```python
import torch

def _softmax(x, axis=-1):
    return torch.softmax(x, dim=axis)
def _gelu(x):
    return torch.nn.functional.gelu(x, approximate="tanh")
def _silu(x):
    return torch.nn.functional.silu(x)
def _sigmoid(x):
    return torch.sigmoid(x)
def _layernorm(x, axis=-1, eps=1e-5):
    m = x.mean(dim=axis, keepdim=True)
    v = x.var(dim=axis, keepdim=True, unbiased=False)
    return (x - m) / torch.sqrt(v + eps)
def _scatter_add(tgt, idx, src, axis=0):
    return tgt.clone().index_add_(axis, idx, src)
def _segment_sum(src, seg, n):
    out = torch.zeros((n,) + src.shape[1:], dtype=src.dtype)
    return out.index_add_(0, seg, src)
def _pad(x, pw):
    flat = tuple(v for pair in reversed(pw) for v in pair)
    return torch.nn.functional.pad(x, flat)

kernel_name = 'concat_heads__grouped_kv_mqa__spectral_fnet__prompt'

def setup_inputs():

    _w = (lambda a: (lambda t: t.to(torch.bfloat16) if t.is_floating_point() else t)(torch.as_tensor(a)))
    def _A_setup():
        B, S, D, H = 1, 2048, 512, 32
        Dh = D // H
        return {
            "x": _w((lambda *s: torch.randn(*s, dtype=torch.bfloat16) * 0.05)(B, S, D)),
            "wq": _w((lambda *s: torch.randn(*s, dtype=torch.bfloat16) * 3.2)(D, H * Dh)),
            "wk": _w((lambda *s: torch.randn(*s, dtype=torch.bfloat16) * 3.2)(D, Dh)),
            "wv": _w((lambda *s: torch.randn(*s, dtype=torch.bfloat16) * 1.6)(D, Dh)),
            "wo": _w((lambda *s: torch.randn(*s, dtype=torch.bfloat16) * 1.6)(H * Dh, D)),
        }
    _A_in = _A_setup()

    def _B_setup():
        B, S, D = 1, 2048, 512
        ns = torch.arange(S)[:, None] * torch.arange(S)[None, :]
        nd = torch.arange(D)[:, None] * torch.arange(D)[None, :]
        Ws_re = torch.cos(-2.0 * torch.pi * ns / S).to(float)
        Ws_im = torch.sin(-2.0 * torch.pi * ns / S).to(float)
        Wd_re = torch.cos(-2.0 * torch.pi * nd / D).to(float)
        Wd_im = torch.sin(-2.0 * torch.pi * nd / D).to(float)
        return {
            "x": _w((lambda *s: torch.randn(*s, dtype=torch.bfloat16) * 0.05)(B, S, D)),
            "dft_seq_re": _w(Ws_re),
            "dft_seq_im": _w(Ws_im),
            "dft_hid_re": _w(Wd_re),
            "dft_hid_im": _w(Wd_im),
        }
    _B_in = _B_setup()

    return {
        "A_x": _A_in["x"],
        "A_wq": _A_in["wq"],
        "A_wk": _A_in["wk"],
        "A_wv": _A_in["wv"],
        "A_wo": _A_in["wo"],
        "B_x": _B_in["x"],
        "B_dft_seq_re": _B_in["dft_seq_re"],
        "B_dft_seq_im": _B_in["dft_seq_im"],
        "B_dft_hid_re": _B_in["dft_hid_re"],
        "B_dft_hid_im": _B_in["dft_hid_im"],
    }

def reference(A_x, A_wq, A_wk, A_wv, A_wo, B_x, B_dft_seq_re, B_dft_seq_im, B_dft_hid_re, B_dft_hid_im):
    def _A_ref(x, wq, wk, wv, wo):
        B, S, D = x.shape
        H = 32
        Dh = D // H
        q = (lambda x, *d: x.permute(*d))((x @ wq).reshape(B, S, H, Dh), 0, 2, 1, 3)
        k = x @ wk
        v = x @ wv
        scores = torch.einsum("bhqd,bkd->bhqk", q, k) * (Dh ** -0.5)
        p = _softmax(scores, axis=-1)
        o = torch.einsum("bhqk,bkd->bhqd", p, v)
        return (lambda x, *d: x.permute(*d))(o, 0, 2, 1, 3).reshape(B, S, H * Dh) @ wo

    def _B_ref(x, dft_seq_re, dft_seq_im, dft_hid_re, dft_hid_im):
        a = torch.einsum("bsd,ed->bse", x, dft_hid_re)
        b = torch.einsum("bsd,ed->bse", x, dft_hid_im)
        y = torch.einsum("ts,bse->bte", dft_seq_re, a) - torch.einsum("ts,bse->bte", dft_seq_im, b)
        return y

    a = _A_ref(A_x, A_wq, A_wk, A_wv, A_wo)
    b = _B_ref(B_x, B_dft_seq_re, B_dft_seq_im, B_dft_hid_re, B_dft_hid_im)
    return torch.concatenate([a, b], axis=-1)
```

```asm
; @launch grid=(256,1,1) block=(768,1,1) lds=163840
.amdgcn_target "amdgcn-amd-amdhsa--gfx950"
.text
.globl concat_heads__grouped_kv_mqa__spectral_fnet__prompt_kernel
.p2align 8
.type concat_heads__grouped_kv_mqa__spectral_fnet__prompt_kernel,@function
concat_heads__grouped_kv_mqa__spectral_fnet__prompt_kernel:
    s_cmp_ge_u32 s2, 256
    s_cbranch_scc1 L_end
    s_load_dwordx16 s[64:79], s[0:1], 0
    s_load_dwordx8 s[80:87], s[0:1], 64
    s_load_dwordx2 s[88:89], s[0:1], 96
    s_getpc_b64 s[90:91]
L_pc:
    s_bfe_u32 s46, s2, 0x30003
    v_lshl_add_u32 v1, v0, 3, s46
    v_lshlrev_b32 v1, 7, v1
    v_cmp_gt_u32 vcc, (dft_tab_end-L_pc)&0xffffff80, v1
    s_and_saveexec_b64 s[46:47], vcc
    s_cbranch_execz L_nopf
    global_load_dword v167, v1, s[90:91]
L_nopf:
    s_mov_b64 exec, -1
    v_lshrrev_b32 v1, 6, v0
    v_and_b32 v0, 63, v0
    v_readfirstlane_b32 s3, v1
    s_and_b32 s37, s2, 7
    s_lshr_b32 s38, s2, 3
    s_lshr_b32 s41, s2, 5
    s_and_b32 s46, s38, 3
    s_lshl_b32 s40, s37, 2
    s_add_u32 s40, s40, s46
    s_lshl_b32 s36, s40, 3
    s_add_u32 s36, s36, s41
    s_lshl_b32 s46, s46, 1
    s_add_u32 s42, s41, s46
    s_add_u32 s42, s42, s37
    s_mov_b32 s39, 0
    s_cmp_lg_u32 s3, 4
    s_cbranch_scc1 L_other
    s_setprio 3
    s_lshr_b32 s47, s41, 1
    s_mov_b32 s48, s47
    v_lshlrev_b32 v7, 4, v0
    s_and_b32 s54, s42, 7
    s_mov_b32 s52, 131072
    s_mov_b32 s53, 8
    s_lshl_b32 s46, s48, 4
    v_lshrrev_b32 v4, 3, v0
    v_add_u32 v4, s46, v4
    v_and_b32 v5, 7, v0
    v_bfe_u32 v6, v4, 1, 3
    v_xor_b32 v6, v5, v6
    v_lshlrev_b32 v6, 4, v6
    v_lshl_add_u32 v8, v4, 10, v6
    v_add_u32 v4, 8, v4
    v_bfe_u32 v6, v4, 1, 3
    v_xor_b32 v6, v5, v6
    v_lshlrev_b32 v6, 4, v6
    v_lshl_add_u32 v9, v4, 10, v6
    s_lshl_b32 s63, s48, 11
    s_mov_b32 s49, 7
    s_lshl_b32 s62, s40, 16
    s_waitcnt lgkmcnt(0)
    s_load_dword s43, s[88:89], 0
    s_mov_b32 s8, s64
    s_mov_b32 s9, s65
    s_mov_b32 s10, 0x200000
    s_mov_b32 s11, 0x00020000
    s_bitcmp0_b32 s41, 0
    s_cselect_b32 s12, s68, s70
    s_cselect_b32 s13, s69, s71
    s_mov_b32 s14, 0x4000
    s_mov_b32 s15, 0x00020000
L_kvdma:
    s_lshl_b32 s46, s54, 7
    s_mov_b32 m0, s63
    s_add_u32 s46, s46, s62
    buffer_load_dwordx4 v8, s[8:11], s46 offen lds
    s_add_u32 m0, s63, 1024
    s_lshl_b32 s50, s54, 11
    buffer_load_dwordx4 v9, s[8:11], s46 offen lds
    s_mov_b32 m0, s52
    s_add_u32 s54, s54, 1
    buffer_load_dwordx4 v7, s[12:15], s50 offen lds
    buffer_load_dwordx4 v7, s[12:15], s50 offen offset:1024 lds
    s_and_b32 s54, s54, 7
    s_add_u32 s63, s63, 8192
    s_add_u32 s52, s52, 2048
    s_sub_u32 s53, s53, 1
    s_cmp_lg_u32 s53, 0
    s_cbranch_scc1 L_kvdma
    s_barrier
    s_branch L_kv2
L_auxpre:
    s_cmp_lg_u32 s3, 8
    s_cbranch_scc1 L_auxpre2
    s_waitcnt lgkmcnt(0)
    s_load_dword s95, s[68:69], 0
    s_load_dword s95, s[70:71], 0
    s_load_dword s95, s[66:67], 0
    s_barrier
    s_branch L_aux
L_auxpre2:
    s_barrier
    s_branch L_aux
L_other:
    s_cmp_ge_u32 s3, 8
    s_cbranch_scc1 L_auxpre
    s_cmp_ge_u32 s3, 4
    s_cbranch_scc1 L_x_1
    s_mov_b32 s48, s3
    s_lshl_b32 s46, s48, 4
    v_lshrrev_b32 v4, 3, v0
    v_add_u32 v4, s46, v4
    v_and_b32 v5, 7, v0
    v_bfe_u32 v6, v4, 1, 1
    v_lshlrev_b32 v6, 2, v6
    v_xor_b32 v6, v5, v6
    v_lshlrev_b32 v6, 4, v6
    v_lshl_add_u32 v8, v4, 10, v6
    v_add_u32 v4, 8, v4
    v_bfe_u32 v6, v4, 1, 1
    v_lshlrev_b32 v6, 2, v6
    v_xor_b32 v6, v5, v6
    v_lshlrev_b32 v6, 4, v6
    v_lshl_add_u32 v9, v4, 10, v6
    s_lshl_b32 s63, s48, 11
    s_add_u32 s63, s63, 65536
    s_mov_b32 s49, 16
    s_lshl_b32 s62, s41, 7
    s_waitcnt lgkmcnt(0)
    s_load_dword s43, s[88:89], 0
    s_mov_b32 s8, s66
    s_mov_b32 s9, s67
    s_mov_b32 s10, 0x80000
    s_mov_b32 s11, 0x00020000
    s_mov_b32 s4, s88
    s_mov_b32 s5, s89
    s_mov_b32 s6, 0x680000
    s_mov_b32 s7, 0x00020000
    s_branch L_ld_2
L_x_1:
    s_lshr_b32 s47, s41, 1
    s_sub_u32 s48, s3, 5
    s_cmp_ge_u32 s48, s47
    s_addc_u32 s48, s48, 0
    s_lshl_b32 s46, s48, 4
    v_lshrrev_b32 v4, 3, v0
    v_add_u32 v4, s46, v4
    v_and_b32 v5, 7, v0
    v_bfe_u32 v6, v4, 1, 3
    v_xor_b32 v6, v5, v6
    v_lshlrev_b32 v6, 4, v6
    v_lshl_add_u32 v8, v4, 10, v6
    v_add_u32 v4, 8, v4
    v_bfe_u32 v6, v4, 1, 3
    v_xor_b32 v6, v5, v6
    v_lshlrev_b32 v6, 4, v6
    v_lshl_add_u32 v9, v4, 10, v6
    s_lshl_b32 s63, s48, 11
    s_mov_b32 s49, 7
    s_lshl_b32 s62, s40, 16
    s_waitcnt lgkmcnt(0)
    s_load_dword s43, s[88:89], 0
    s_mov_b32 s8, s64
    s_mov_b32 s9, s65
    s_mov_b32 s10, 0x200000
    s_mov_b32 s11, 0x00020000
    s_mov_b32 s4, s88
    s_mov_b32 s5, s89
    s_mov_b32 s6, 0x680000
    s_mov_b32 s7, 0x00020000
L_ld_2:
    s_barrier
    s_cmp_lg_u32 s3, 1
    s_cbranch_scc1 L_td_3
    v_mov_b32 v4, 77824
    s_mov_b64 exec, 1
    buffer_load_dword v10, v4, s[4:7], 0 offen
    s_mov_b64 exec, -1
L_td_3:
    s_add_u32 s46, s42, 0
    s_and_b32 s46, s46, 7
    s_lshl_b32 s46, s46, s49
    s_add_u32 m0, s63, 0
    s_add_u32 s46, s46, s62
    buffer_load_dwordx4 v8, s[8:11], s46 offen lds
    s_add_u32 m0, s63, 1024
    s_nop 0
    buffer_load_dwordx4 v9, s[8:11], s46 offen lds
    s_add_u32 s46, s42, 1
    s_and_b32 s46, s46, 7
    s_lshl_b32 s46, s46, s49
    s_add_u32 m0, s63, 8192
    s_add_u32 s46, s46, s62
    buffer_load_dwordx4 v8, s[8:11], s46 offen lds
    s_add_u32 m0, s63, 9216
    s_nop 0
    buffer_load_dwordx4 v9, s[8:11], s46 offen lds
    v_and_b32 v165, 1, v0
    v_lshlrev_b32 v165, 1, v165
    s_lshl_b32 s46, s3, 5
    s_mov_b32 exec_hi, 0
    v_add_u32 v165, s46, v0
    s_mov_b32 exec_hi, -1
    v_lshlrev_b32 v165, 7, v165
    v_add_u32 v165, 4096, v165
    s_cmp_lg_u32 s3, 7
    s_cbranch_scc1 L_nz_4
    v_and_b32 v4, 31, v0
    v_and_b32 v5, 28, v0
    v_cmp_eq_u32 vcc, 12, v5
    v_lshlrev_b32 v4, 2, v4
    v_add_u32 v4, 161792, v4
    v_cndmask_b32_e64 v5, 0, 0, vcc
    ds_write_b32 v4, v5
L_nz_4:
    v_lshlrev_b32 v1, 4, v0
    v_lshlrev_b32 v160, 4, v0
    v_add_u32 v160, 147456, v160
    v_and_b32 v161, 31, v0
    v_lshlrev_b32 v161, 4, v161
    v_add_u32 v161, 155648, v161
    s_lshl_b32 s46, s3, 2
    s_add_u32 s46, s46, 161776
    v_mov_b32 v163, s46
    v_and_b32 v162, 3, v0
    v_lshlrev_b32 v162, 2, v162
    v_add_u32 v162, 161840, v162
    s_mov_b32 s44, 0
    v_and_b32 v3, 31, v0
    v_lshlrev_b32 v3, 2, v3
    s_lshl_b32 s56, s3, 11
    s_lshl_b32 s59, s3, 7
    s_lshl_b32 s47, s3, 13
    s_add_u32 s57, s47, 131072
    s_add_u32 s58, s47, 196608
    v_and_b32 v4, 11, v0
    v_cmp_eq_u32 vcc, 0, v4
    v_mov_b32 v5, 0x49804980
    s_nop 0
    v_cndmask_b32 v4, 0, v5, vcc
    v_mov_b32 v36, v4
    v_mov_b32 v37, v4
    v_mov_b32 v38, v4
    v_mov_b32 v39, v4
    v_mov_b32 v40, v4
    v_mov_b32 v41, v4
    v_mov_b32 v42, v4
    v_mov_b32 v43, v4
    v_mov_b32 v44, v4
    v_mov_b32 v45, v4
    v_mov_b32 v46, v4
    v_mov_b32 v47, v4
    v_mov_b32 v48, v4
    v_mov_b32 v49, v4
    v_mov_b32 v50, v4
    v_mov_b32 v51, v4
    v_mov_b32 v52, v4
    v_mov_b32 v53, v4
    v_mov_b32 v54, v4
    v_mov_b32 v55, v4
    v_mov_b32 v56, v4
    v_mov_b32 v57, v4
    v_mov_b32 v58, v4
    v_mov_b32 v59, v4
    v_mov_b32 v60, v4
    v_mov_b32 v61, v4
    v_mov_b32 v62, v4
    v_mov_b32 v63, v4
    v_mov_b32 v64, v4
    v_mov_b32 v65, v4
    v_mov_b32 v66, v4
    v_mov_b32 v67, v4
    v_mov_b32 v68, v4
    v_mov_b32 v69, v4
    v_mov_b32 v70, v4
    v_mov_b32 v71, v4
    v_mov_b32 v72, v4
    v_mov_b32 v73, v4
    v_mov_b32 v74, v4
    v_mov_b32 v75, v4
    v_mov_b32 v76, v4
    v_mov_b32 v77, v4
    v_mov_b32 v78, v4
    v_mov_b32 v79, v4
    v_mov_b32 v80, v4
    v_mov_b32 v81, v4
    v_mov_b32 v82, v4
    v_mov_b32 v83, v4
    v_mov_b32 v84, v4
    v_mov_b32 v85, v4
    v_mov_b32 v86, v4
    v_mov_b32 v87, v4
    v_mov_b32 v88, v4
    v_mov_b32 v89, v4
    v_mov_b32 v90, v4
    v_mov_b32 v91, v4
    v_mov_b32 v92, v4
    v_mov_b32 v93, v4
    v_mov_b32 v94, v4
    v_mov_b32 v95, v4
    v_mov_b32 v96, v4
    v_mov_b32 v97, v4
    v_mov_b32 v98, v4
    v_mov_b32 v99, v4
    s_mov_b32 s30, 0xffff
    s_mov_b32 s31, 0xffff
    s_waitcnt lgkmcnt(0)
    s_andn2_b32 s43, s43, 3
    s_add_u32 s43, s43, 4
    s_mov_b32 s60, -1
    s_mov_b32 s61, 3
    s_cmp_lg_u32 s3, 6
    s_cbranch_scc1 L_no_5
    s_load_dword s95, s[72:73], 0
L_no_5:
    s_cmp_lg_u32 s3, 0
    s_cbranch_scc1 L_hopn_7
    s_call_b64 s[100:101], H_att
    s_branch L_hopd_6
L_hopn_7:
    s_cmp_lg_u32 s3, 1
    s_cbranch_scc1 L_hopn_8
    s_call_b64 s[100:101], H_m0
    s_branch L_hopd_6
L_hopn_8:
    s_cmp_lg_u32 s3, 2
    s_cbranch_scc1 L_hopn_9
    s_call_b64 s[100:101], H_t1
    s_branch L_hopd_6
L_hopn_9:
    s_cmp_lg_u32 s3, 3
    s_cbranch_scc1 L_hopn_10
    s_call_b64 s[100:101], H_m1
    s_branch L_hopd_6
L_hopn_10:
    s_cmp_lg_u32 s3, 5
    s_cbranch_scc1 L_hopn_11
    s_call_b64 s[100:101], H_ool
    s_branch L_hopd_6
L_hopn_11:
    s_cmp_lg_u32 s3, 6
    s_cbranch_scc1 L_hopn_12
    s_call_b64 s[100:101], H_a2
    s_branch L_hopd_6
L_hopn_12:
    s_cmp_lg_u32 s3, 7
    s_cbranch_scc1 L_hopn_13
    s_call_b64 s[100:101], H_ex
    s_branch L_hopd_6
L_hopn_13:
L_hopd_6:
    s_barrier
    s_add_u32 s46, s42, 2
    s_and_b32 s46, s46, 7
    s_lshl_b32 s46, s46, s49
    s_add_u32 m0, s63, 16384
    s_add_u32 s46, s46, s62
    buffer_load_dwordx4 v8, s[8:11], s46 offen lds
    s_add_u32 m0, s63, 17408
    s_nop 0
    buffer_load_dwordx4 v9, s[8:11], s46 offen lds
    s_add_u32 s46, s42, 3
    s_and_b32 s46, s46, 7
    s_lshl_b32 s46, s46, s49
    s_add_u32 m0, s63, 24576
    s_add_u32 s46, s46, s62
    buffer_load_dwordx4 v8, s[8:11], s46 offen lds
    s_add_u32 m0, s63, 25600
    s_nop 0
    buffer_load_dwordx4 v9, s[8:11], s46 offen lds
    s_waitcnt vmcnt(4)
    s_barrier
    s_add_u32 s46, s42, 4
    s_and_b32 s46, s46, 7
    s_lshl_b32 s46, s46, s49
    s_add_u32 m0, s63, 32768
    s_add_u32 s46, s46, s62
    buffer_load_dwordx4 v8, s[8:11], s46 offen lds
    s_add_u32 m0, s63, 33792
    s_nop 0
    buffer_load_dwordx4 v9, s[8:11], s46 offen lds
    s_add_u32 s46, s42, 5
    s_and_b32 s46, s46, 7
    s_lshl_b32 s46, s46, s49
    s_add_u32 m0, s63, 40960
    s_add_u32 s46, s46, s62
    buffer_load_dwordx4 v8, s[8:11], s46 offen lds
    s_add_u32 m0, s63, 41984
    s_nop 0
    buffer_load_dwordx4 v9, s[8:11], s46 offen lds
    s_waitcnt vmcnt(4)
    s_barrier
    s_add_u32 s46, s42, 6
    s_and_b32 s46, s46, 7
    s_lshl_b32 s46, s46, s49
    s_add_u32 m0, s63, 49152
    s_add_u32 s46, s46, s62
    buffer_load_dwordx4 v8, s[8:11], s46 offen lds
    s_add_u32 m0, s63, 50176
    s_nop 0
    buffer_load_dwordx4 v9, s[8:11], s46 offen lds
    s_add_u32 s46, s42, 7
    s_and_b32 s46, s46, 7
    s_lshl_b32 s46, s46, s49
    s_add_u32 m0, s63, 57344
    s_add_u32 s46, s46, s62
    buffer_load_dwordx4 v8, s[8:11], s46 offen lds
    s_add_u32 m0, s63, 58368
    s_nop 0
    buffer_load_dwordx4 v9, s[8:11], s46 offen lds
    s_waitcnt vmcnt(4)
    s_barrier
    s_mov_b64 exec, s[60:61]
    buffer_load_dword v166, v165, s[4:7], 0 offen sc1
    s_mov_b64 exec, -1
    s_waitcnt vmcnt(1)
    s_barrier
    s_branch L_att
L_kv2:
    v_and_b32 v165, 1, v0
    v_lshlrev_b32 v165, 1, v165
    s_lshl_b32 s46, s3, 5
    s_mov_b32 exec_hi, 0
    v_add_u32 v165, s46, v0
    s_mov_b32 exec_hi, -1
    v_lshlrev_b32 v165, 7, v165
    v_add_u32 v165, 4096, v165
    s_mov_b32 s4, s88
    s_mov_b32 s5, s89
    s_mov_b32 s6, 0x680000
    s_mov_b32 s7, 0x00020000
    v_and_b32 v4, 15, v0
    v_lshrrev_b32 v6, 4, v0
    s_lshl_b32 s46, s47, 4
    v_add_u32 v5, s46, v4
    v_bfe_u32 v7, v5, 1, 3
    v_xor_b32 v7, v7, v6
    v_lshlrev_b32 v5, 7, v5
    v_lshl_add_u32 v10, v7, 4, v5
    v_xor_b32 v7, 4, v7
    v_lshl_add_u32 v11, v7, 4, v5
    v_bfe_u32 v5, v0, 2, 2
    v_lshl_add_u32 v5, v6, 3, v5
    v_lshlrev_b32 v5, 5, v5
    v_and_b32 v7, 3, v0
    v_lshl_add_u32 v5, v7, 3, v5
    v_add_u32 v14, 131072, v5
    v_and_b32 v5, 1, v6
    v_lshlrev_b32 v5, 9, v5
    v_lshl_add_u32 v5, v4, 4, v5
    v_mov_b32 v15, v5
    s_lshr_b32 s48, s36, 1
    s_lshr_b32 s46, s48, 1
    s_lshl_b32 s46, s46, 10
    s_and_b32 s47, s48, 1
    s_lshl_b32 s47, s47, 8
    s_add_u32 s51, s46, s47
    s_and_b32 s46, s41, 1
    s_lshl_b32 s46, s46, 16
    s_add_u32 s51, s51, s46
    s_add_u32 s51, s51, 131072
    s_bitcmp1_b32 s41, 0
    s_cselect_b32 s52, 0x49800000, 1.0
    s_lshr_b32 s48, s36, 1
    s_lshl_b32 s50, s36, 7
    s_add_u32 s50, s50, 4096
    s_waitcnt lgkmcnt(0)
    s_andn2_b32 s43, s43, 3
    s_add_u32 s43, s43, 4
    s_bitcmp1_b32 s41, 0
    s_cbranch_scc1 L_v_14
    s_waitcnt vmcnt(28)
    ds_read_b128 v[124:127], v10 offset:0
    ds_read_b64_tr_b16 v[100:101], v14 offset:0
    ds_read_b64_tr_b16 v[102:103], v14 offset:128
    ds_read_b128 v[128:131], v11 offset:0
    ds_read_b64_tr_b16 v[104:105], v14 offset:1024
    ds_read_b64_tr_b16 v[106:107], v14 offset:1152
    s_waitcnt vmcnt(24)
    ds_read_b128 v[132:135], v10 offset:8192
    ds_read_b64_tr_b16 v[108:109], v14 offset:2048
    ds_read_b64_tr_b16 v[110:111], v14 offset:2176
    ds_read_b128 v[136:139], v11 offset:8192
    ds_read_b64_tr_b16 v[112:113], v14 offset:3072
    ds_read_b64_tr_b16 v[114:115], v14 offset:3200
    s_waitcnt lgkmcnt(6)
    v_mfma_f32_16x16x32_bf16 v[16:19], v[100:103], v[124:127], 0
    v_mfma_f32_16x16x32_bf16 v[16:19], v[104:107], v[128:131], v[16:19]
    s_waitcnt vmcnt(20)
    ds_read_b128 v[124:127], v10 offset:16384
    ds_read_b64_tr_b16 v[100:101], v14 offset:4096
    ds_read_b64_tr_b16 v[102:103], v14 offset:4224
    ds_read_b128 v[128:131], v11 offset:16384
    ds_read_b64_tr_b16 v[104:105], v14 offset:5120
    ds_read_b64_tr_b16 v[106:107], v14 offset:5248
    s_waitcnt lgkmcnt(6)
    v_mfma_f32_16x16x32_bf16 v[16:19], v[108:111], v[132:135], v[16:19]
    v_mfma_f32_16x16x32_bf16 v[16:19], v[112:115], v[136:139], v[16:19]
    s_waitcnt vmcnt(16)
    ds_read_b128 v[132:135], v10 offset:24576
    ds_read_b64_tr_b16 v[108:109], v14 offset:6144
    ds_read_b64_tr_b16 v[110:111], v14 offset:6272
    ds_read_b128 v[136:139], v11 offset:24576
    ds_read_b64_tr_b16 v[112:113], v14 offset:7168
    ds_read_b64_tr_b16 v[114:115], v14 offset:7296
    s_waitcnt lgkmcnt(6)
    v_mfma_f32_16x16x32_bf16 v[16:19], v[100:103], v[124:127], v[16:19]
    v_mfma_f32_16x16x32_bf16 v[16:19], v[104:107], v[128:131], v[16:19]
    s_waitcnt vmcnt(12)
    ds_read_b128 v[124:127], v10 offset:32768
    ds_read_b64_tr_b16 v[100:101], v14 offset:8192
    ds_read_b64_tr_b16 v[102:103], v14 offset:8320
    ds_read_b128 v[128:131], v11 offset:32768
    ds_read_b64_tr_b16 v[104:105], v14 offset:9216
    ds_read_b64_tr_b16 v[106:107], v14 offset:9344
    s_waitcnt lgkmcnt(6)
    v_mfma_f32_16x16x32_bf16 v[16:19], v[108:111], v[132:135], v[16:19]
    v_mfma_f32_16x16x32_bf16 v[16:19], v[112:115], v[136:139], v[16:19]
    s_waitcnt vmcnt(8)
    ds_read_b128 v[132:135], v10 offset:40960
    ds_read_b64_tr_b16 v[108:109], v14 offset:10240
    ds_read_b64_tr_b16 v[110:111], v14 offset:10368
    ds_read_b128 v[136:139], v11 offset:40960
    ds_read_b64_tr_b16 v[112:113], v14 offset:11264
    ds_read_b64_tr_b16 v[114:115], v14 offset:11392
    s_waitcnt lgkmcnt(6)
    v_mfma_f32_16x16x32_bf16 v[16:19], v[100:103], v[124:127], v[16:19]
    v_mfma_f32_16x16x32_bf16 v[16:19], v[104:107], v[128:131], v[16:19]
    s_waitcnt vmcnt(4)
    ds_read_b128 v[124:127], v10 offset:49152
    ds_read_b64_tr_b16 v[100:101], v14 offset:12288
    ds_read_b64_tr_b16 v[102:103], v14 offset:12416
    ds_read_b128 v[128:131], v11 offset:49152
    ds_read_b64_tr_b16 v[104:105], v14 offset:13312
    ds_read_b64_tr_b16 v[106:107], v14 offset:13440
    s_waitcnt lgkmcnt(6)
    v_mfma_f32_16x16x32_bf16 v[16:19], v[108:111], v[132:135], v[16:19]
    v_mfma_f32_16x16x32_bf16 v[16:19], v[112:115], v[136:139], v[16:19]
    s_waitcnt vmcnt(0)
    ds_read_b128 v[132:135], v10 offset:57344
    ds_read_b64_tr_b16 v[108:109], v14 offset:14336
    ds_read_b64_tr_b16 v[110:111], v14 offset:14464
    ds_read_b128 v[136:139], v11 offset:57344
    ds_read_b64_tr_b16 v[112:113], v14 offset:15360
    ds_read_b64_tr_b16 v[114:115], v14 offset:15488
    s_waitcnt lgkmcnt(6)
    v_mfma_f32_16x16x32_bf16 v[16:19], v[100:103], v[124:127], v[16:19]
    v_mfma_f32_16x16x32_bf16 v[16:19], v[104:107], v[128:131], v[16:19]
    s_waitcnt lgkmcnt(0)
    v_mfma_f32_16x16x32_bf16 v[16:19], v[108:111], v[132:135], v[16:19]
    v_mfma_f32_16x16x32_bf16 v[16:19], v[112:115], v[136:139], v[16:19]
    s_branch L_kvf_15
L_v_14:
    s_waitcnt vmcnt(28)
    ds_read_b128 v[124:127], v10 offset:0
    ds_read_b64_tr_b16 v[100:101], v14 offset:0
    ds_read_b64_tr_b16 v[102:103], v14 offset:128
    ds_read_b128 v[128:131], v11 offset:0
    ds_read_b64_tr_b16 v[104:105], v14 offset:1024
    ds_read_b64_tr_b16 v[106:107], v14 offset:1152
    s_waitcnt vmcnt(24)
    ds_read_b128 v[132:135], v10 offset:8192
    ds_read_b64_tr_b16 v[108:109], v14 offset:2048
    ds_read_b64_tr_b16 v[110:111], v14 offset:2176
    ds_read_b128 v[136:139], v11 offset:8192
    ds_read_b64_tr_b16 v[112:113], v14 offset:3072
    ds_read_b64_tr_b16 v[114:115], v14 offset:3200
    s_waitcnt lgkmcnt(6)
    v_mfma_f32_16x16x32_bf16 v[16:19], v[124:127], v[100:103], 0
    v_mfma_f32_16x16x32_bf16 v[16:19], v[128:131], v[104:107], v[16:19]
    s_waitcnt vmcnt(20)
    ds_read_b128 v[124:127], v10 offset:16384
    ds_read_b64_tr_b16 v[100:101], v14 offset:4096
    ds_read_b64_tr_b16 v[102:103], v14 offset:4224
    ds_read_b128 v[128:131], v11 offset:16384
    ds_read_b64_tr_b16 v[104:105], v14 offset:5120
    ds_read_b64_tr_b16 v[106:107], v14 offset:5248
    s_waitcnt lgkmcnt(6)
    v_mfma_f32_16x16x32_bf16 v[16:19], v[132:135], v[108:111], v[16:19]
    v_mfma_f32_16x16x32_bf16 v[16:19], v[136:139], v[112:115], v[16:19]
    s_waitcnt vmcnt(16)
    ds_read_b128 v[132:135], v10 offset:24576
    ds_read_b64_tr_b16 v[108:109], v14 offset:6144
    ds_read_b64_tr_b16 v[110:111], v14 offset:6272
    ds_read_b128 v[136:139], v11 offset:24576
    ds_read_b64_tr_b16 v[112:113], v14 offset:7168
    ds_read_b64_tr_b16 v[114:115], v14 offset:7296
    s_waitcnt lgkmcnt(6)
    v_mfma_f32_16x16x32_bf16 v[16:19], v[124:127], v[100:103], v[16:19]
    v_mfma_f32_16x16x32_bf16 v[16:19], v[128:131], v[104:107], v[16:19]
    s_waitcnt vmcnt(12)
    ds_read_b128 v[124:127], v10 offset:32768
    ds_read_b64_tr_b16 v[100:101], v14 offset:8192
    ds_read_b64_tr_b16 v[102:103], v14 offset:8320
    ds_read_b128 v[128:131], v11 offset:32768
    ds_read_b64_tr_b16 v[104:105], v14 offset:9216
    ds_read_b64_tr_b16 v[106:107], v14 offset:9344
    s_waitcnt lgkmcnt(6)
    v_mfma_f32_16x16x32_bf16 v[16:19], v[132:135], v[108:111], v[16:19]
    v_mfma_f32_16x16x32_bf16 v[16:19], v[136:139], v[112:115], v[16:19]
    s_waitcnt vmcnt(8)
    ds_read_b128 v[132:135], v10 offset:40960
    ds_read_b64_tr_b16 v[108:109], v14 offset:10240
    ds_read_b64_tr_b16 v[110:111], v14 offset:10368
    ds_read_b128 v[136:139], v11 offset:40960
    ds_read_b64_tr_b16 v[112:113], v14 offset:11264
    ds_read_b64_tr_b16 v[114:115], v14 offset:11392
    s_waitcnt lgkmcnt(6)
    v_mfma_f32_16x16x32_bf16 v[16:19], v[124:127], v[100:103], v[16:19]
    v_mfma_f32_16x16x32_bf16 v[16:19], v[128:131], v[104:107], v[16:19]
    s_waitcnt vmcnt(4)
    ds_read_b128 v[124:127], v10 offset:49152
    ds_read_b64_tr_b16 v[100:101], v14 offset:12288
    ds_read_b64_tr_b16 v[102:103], v14 offset:12416
    ds_read_b128 v[128:131], v11 offset:49152
    ds_read_b64_tr_b16 v[104:105], v14 offset:13312
    ds_read_b64_tr_b16 v[106:107], v14 offset:13440
    s_waitcnt lgkmcnt(6)
    v_mfma_f32_16x16x32_bf16 v[16:19], v[132:135], v[108:111], v[16:19]
    v_mfma_f32_16x16x32_bf16 v[16:19], v[136:139], v[112:115], v[16:19]
    s_waitcnt vmcnt(0)
    ds_read_b128 v[132:135], v10 offset:57344
    ds_read_b64_tr_b16 v[108:109], v14 offset:14336
    ds_read_b64_tr_b16 v[110:111], v14 offset:14464
    ds_read_b128 v[136:139], v11 offset:57344
    ds_read_b64_tr_b16 v[112:113], v14 offset:15360
    ds_read_b64_tr_b16 v[114:115], v14 offset:15488
    s_waitcnt lgkmcnt(6)
    v_mfma_f32_16x16x32_bf16 v[16:19], v[124:127], v[100:103], v[16:19]
    v_mfma_f32_16x16x32_bf16 v[16:19], v[128:131], v[104:107], v[16:19]
    s_waitcnt lgkmcnt(0)
    v_mfma_f32_16x16x32_bf16 v[16:19], v[132:135], v[108:111], v[16:19]
    v_mfma_f32_16x16x32_bf16 v[16:19], v[136:139], v[112:115], v[16:19]
L_kvf_15:
    s_nop 7
    v_mul_f32 v16, s52, v16
    v_mul_f32 v17, s52, v17
    v_mul_f32 v18, s52, v18
    v_mul_f32 v19, s52, v19
    v_cvt_pk_bf16_f32 v24, v16, v17
    v_cvt_pk_bf16_f32 v25, v18, v19
    s_nop 1
    v_permlane32_swap_b32 v24, v26
    v_permlane32_swap_b32 v25, v27
    s_mov_b32 exec_hi, 0
    buffer_store_dwordx4 v[24:27], v15, s[4:7], s51 offen sc1
    s_mov_b32 exec_hi, -1
    s_barrier
    s_waitcnt vmcnt(0)
    v_mov_b32 v4, 0
    v_mov_b32 v5, s43
    s_mov_b64 exec, 1
    buffer_store_dword v5, v4, s[4:7], s50 offen sc1
    s_mov_b64 exec, -1
    v_lshlrev_b32 v1, 4, v0
    v_lshlrev_b32 v160, 4, v0
    v_add_u32 v160, 147456, v160
    v_and_b32 v161, 31, v0
    v_lshlrev_b32 v161, 4, v161
    v_add_u32 v161, 155648, v161
    s_lshl_b32 s46, s3, 2
    s_add_u32 s46, s46, 161776
    v_mov_b32 v163, s46
    v_and_b32 v162, 3, v0
    v_lshlrev_b32 v162, 2, v162
    v_add_u32 v162, 161840, v162
    s_mov_b32 s44, 0
    v_and_b32 v3, 31, v0
    v_lshlrev_b32 v3, 2, v3
    s_lshl_b32 s56, s3, 11
    s_lshl_b32 s59, s3, 7
    s_lshl_b32 s47, s3, 13
    s_add_u32 s57, s47, 131072
    s_add_u32 s58, s47, 196608
    v_and_b32 v4, 11, v0
    v_cmp_eq_u32 vcc, 0, v4
    v_mov_b32 v5, 0x49804980
    s_nop 0
    v_cndmask_b32 v4, 0, v5, vcc
    v_mov_b32 v36, v4
    v_mov_b32 v37, v4
    v_mov_b32 v38, v4
    v_mov_b32 v39, v4
    v_mov_b32 v40, v4
    v_mov_b32 v41, v4
    v_mov_b32 v42, v4
    v_mov_b32 v43, v4
    v_mov_b32 v44, v4
    v_mov_b32 v45, v4
    v_mov_b32 v46, v4
    v_mov_b32 v47, v4
    v_mov_b32 v48, v4
    v_mov_b32 v49, v4
    v_mov_b32 v50, v4
    v_mov_b32 v51, v4
    v_mov_b32 v52, v4
    v_mov_b32 v53, v4
    v_mov_b32 v54, v4
    v_mov_b32 v55, v4
    v_mov_b32 v56, v4
    v_mov_b32 v57, v4
    v_mov_b32 v58, v4
    v_mov_b32 v59, v4
    v_mov_b32 v60, v4
    v_mov_b32 v61, v4
    v_mov_b32 v62, v4
    v_mov_b32 v63, v4
    v_mov_b32 v64, v4
    v_mov_b32 v65, v4
    v_mov_b32 v66, v4
    v_mov_b32 v67, v4
    v_mov_b32 v68, v4
    v_mov_b32 v69, v4
    v_mov_b32 v70, v4
    v_mov_b32 v71, v4
    v_mov_b32 v72, v4
    v_mov_b32 v73, v4
    v_mov_b32 v74, v4
    v_mov_b32 v75, v4
    v_mov_b32 v76, v4
    v_mov_b32 v77, v4
    v_mov_b32 v78, v4
    v_mov_b32 v79, v4
    v_mov_b32 v80, v4
    v_mov_b32 v81, v4
    v_mov_b32 v82, v4
    v_mov_b32 v83, v4
    v_mov_b32 v84, v4
    v_mov_b32 v85, v4
    v_mov_b32 v86, v4
    v_mov_b32 v87, v4
    v_mov_b32 v88, v4
    v_mov_b32 v89, v4
    v_mov_b32 v90, v4
    v_mov_b32 v91, v4
    v_mov_b32 v92, v4
    v_mov_b32 v93, v4
    v_mov_b32 v94, v4
    v_mov_b32 v95, v4
    v_mov_b32 v96, v4
    v_mov_b32 v97, v4
    v_mov_b32 v98, v4
    v_mov_b32 v99, v4
    s_mov_b32 s30, 0xffff
    s_mov_b32 s31, 0xffff
    s_barrier
    s_barrier
    s_barrier
    s_mov_b32 exec_hi, 0x3
    buffer_load_dword v166, v165, s[4:7], 0 offen sc1
    s_mov_b64 exec, -1
    s_barrier
    s_branch H_att_skip
H_att:
    s_setpc_b64 s[100:101]
H_att_skip:
L_att:
    s_lshr_b32 s32, s3, 2
    s_cmp_lt_u32 s3, 2
    s_cselect_b32 s35, 9, 9
    s_mov_b32 s33, 0
    s_and_b32 s34, s38, 3
    s_lshl_b32 s34, s34, 3
    s_add_u32 s34, s34, s37
    s_setprio 1
    s_cmp_eq_u32 s32, 0
    s_cbranch_scc1 L_lo_16
    s_setprio 2
L_lo_16:
    s_mov_b32 exec_hi, 0x3
    s_waitcnt vmcnt(0)
    s_mov_b32 s55, 0x20000
L_gp_17:
    v_cmp_ne_u32 vcc, s43, v166
    s_cmp_eq_u64 vcc, 0
    s_cbranch_scc1 L_gpd_18
    s_sleep 2
    buffer_load_dword v166, v165, s[4:7], 0 offen sc1
    s_waitcnt vmcnt(0)
    s_sub_u32 s55, s55, 1
    s_cbranch_scc0 L_gp_17
L_gpd_18:
    s_mov_b64 exec, -1
    s_mov_b32 s48, 131072
    s_and_b32 s50, s38, 7
    s_lshl_b32 s50, s50, 10
    s_add_u32 s51, s50, s57
    buffer_load_dwordx4 v[116:119], v1, s[4:7], s48 offen sc1
    buffer_load_dwordx4 v[4:7], v1, s[4:7], s51 offen sc1
    s_add_u32 s51, s50, s58
    s_mov_b64 exec, s[30:31]
    buffer_load_dwordx4 v[36:39], v1, s[4:7], s51 offen sc1
    buffer_load_dwordx4 v[40:43], v1, s[4:7], s51 offen offset:256 sc1
    s_mov_b64 exec, -1
    s_add_u32 s50, s50, 1024
    s_and_b32 s50, s50, 8191
    s_add_u32 s51, s50, s57
    buffer_load_dwordx4 v[8:11], v1, s[4:7], s51 offen sc1
    s_add_u32 s51, s50, s58
    s_mov_b64 exec, s[30:31]
    buffer_load_dwordx4 v[44:47], v1, s[4:7], s51 offen sc1
    buffer_load_dwordx4 v[48:51], v1, s[4:7], s51 offen offset:256 sc1
    s_mov_b64 exec, -1
    s_add_u32 s50, s50, 1024
    s_and_b32 s50, s50, 8191
    s_add_u32 s51, s50, s57
    buffer_load_dwordx4 v[12:15], v1, s[4:7], s51 offen sc1
    v_mov_b32 v165, 161832
    s_mov_b32 s55, 0x40000
    s_lshl_b32 s46, s41, 10
    s_add_u32 s46, s46, 139264
    v_add_u32 v167, s46, v1
L_qw_19:
    ds_read_b32 v166, v165
    ds_read_b128 v[156:159], v167
    s_waitcnt lgkmcnt(1)
    v_readfirstlane_b32 s46, v166
    s_cmp_ge_u32 s46, 4
    s_cbranch_scc1 L_qwok_20
    s_sleep 1
    s_sub_u32 s55, s55, 1
    s_cbranch_scc0 L_qw_19
L_qwok_20:
    s_setprio 3
    s_cmp_lg_u32 s32, 0
    s_cbranch_scc1 L_hi_21
    s_setprio 2
L_hi_21:
    s_waitcnt vmcnt(7) lgkmcnt(0)
    v_mfma_f32_32x32x16_bf16 v[100:115], v[116:119], v[156:159], 0
    s_add_u32 s51, s50, s58
    s_mov_b64 exec, s[30:31]
    buffer_load_dwordx4 v[52:55], v1, s[4:7], s51 offen sc1
    buffer_load_dwordx4 v[56:59], v1, s[4:7], s51 offen offset:256 sc1
    s_mov_b64 exec, -1
    s_add_u32 s50, s50, 1024
    s_and_b32 s50, s50, 8191
    s_add_u32 s51, s50, s57
    buffer_load_dwordx4 v[16:19], v1, s[4:7], s51 offen sc1
    s_mov_b64 vcc, -1
    s_nop 7
    s_nop 2
    v_max3_f32 v166, v100, v101, v102
    v_max3_f32 v166, v166, v103, v104
    v_max3_f32 v166, v166, v105, v106
    v_max3_f32 v166, v166, v107, v108
    v_max3_f32 v166, v166, v109, v110
    v_max3_f32 v166, v166, v111, v112
    v_max3_f32 v166, v166, v113, v114
    v_max_f32 v166, v166, v115
    v_mov_b32 v167, v166
    s_nop 1
    v_permlane32_swap_b32 v166, v167
    s_nop 1
    v_max_f32 v166, v166, v167
    v_sub_f32 v140, 0xc2d00000, v166
    v_mov_b32 v141, v140
    v_mov_b32 v142, v140
    v_mov_b32 v143, v140
    v_mov_b32 v144, v140
    v_mov_b32 v145, v140
    v_mov_b32 v146, v140
    v_mov_b32 v147, v140
    v_mov_b32 v148, v140
    v_mov_b32 v149, v140
    v_mov_b32 v150, v140
    v_mov_b32 v151, v140
    v_mov_b32 v152, v140
    v_mov_b32 v153, v140
    v_mov_b32 v154, v140
    v_mov_b32 v155, v140
    s_waitcnt vmcnt(6)
    s_nop 0
L_att_go:
    s_waitcnt lgkmcnt(0)
    v_mfma_f32_32x32x16_bf16 v[100:115], v[4:7], v[156:159], v[140:155]
    s_setprio 0
    s_nop 7
    s_nop 2
    s_branch L_att_body0
H_a2:
    s_setpc_b64 s[100:101]
.p2align 6
L_att_top0:
    s_cbranch_vccnz L_ool_22
L_back_23:
    s_nop 7
    v_exp_f32 v100, v100
    v_exp_f32 v101, v101
    v_exp_f32 v102, v102
    v_cvt_pk_bf16_f32 v116, v100, v101
    v_exp_f32 v103, v103
    s_setprio 1
    v_exp_f32 v104, v104
    v_cvt_pk_bf16_f32 v117, v102, v103
    v_exp_f32 v105, v105
    v_exp_f32 v106, v106
    v_cvt_pk_bf16_f32 v118, v104, v105
    v_exp_f32 v107, v107
    v_exp_f32 v108, v108
    v_cvt_pk_bf16_f32 v119, v106, v107
    v_exp_f32 v109, v109
    v_exp_f32 v110, v110
    v_cvt_pk_bf16_f32 v120, v108, v109
    v_mfma_f32_32x32x16_bf16 v[124:139], v[52:55], v[116:119], v[124:139]
    v_exp_f32 v111, v111
    v_exp_f32 v112, v112
    v_cvt_pk_bf16_f32 v121, v110, v111
    v_exp_f32 v113, v113
    v_exp_f32 v114, v114
    v_exp_f32 v115, v115
    v_cvt_pk_bf16_f32 v122, v112, v113
    v_cvt_pk_bf16_f32 v123, v114, v115
    s_setprio 3
    v_mfma_f32_32x32x16_bf16 v[100:115], v[16:19], v[156:159], v[140:155]
    v_mfma_f32_32x32x16_bf16 v[124:139], v[56:59], v[120:123], v[124:139]
    s_setprio 0
    s_cbranch_vccnz L_ool_24
L_back_25:
    s_nop 7
    s_nop 0
    v_exp_f32 v100, v100
    v_exp_f32 v101, v101
    v_exp_f32 v102, v102
    v_cvt_pk_bf16_f32 v116, v100, v101
    v_exp_f32 v103, v103
    s_setprio 1
    v_exp_f32 v104, v104
    v_cvt_pk_bf16_f32 v117, v102, v103
    v_exp_f32 v105, v105
    v_exp_f32 v106, v106
    v_cvt_pk_bf16_f32 v118, v104, v105
    v_exp_f32 v107, v107
    v_exp_f32 v108, v108
    v_cvt_pk_bf16_f32 v119, v106, v107
    v_exp_f32 v109, v109
    v_exp_f32 v110, v110
    v_cvt_pk_bf16_f32 v120, v108, v109
    v_mfma_f32_32x32x16_bf16 v[124:139], v[60:63], v[116:119], v[124:139]
    v_exp_f32 v111, v111
    v_exp_f32 v112, v112
    v_cvt_pk_bf16_f32 v121, v110, v111
    v_exp_f32 v113, v113
    v_exp_f32 v114, v114
    v_exp_f32 v115, v115
    v_cvt_pk_bf16_f32 v122, v112, v113
    v_cvt_pk_bf16_f32 v123, v114, v115
    s_setprio 3
    v_mfma_f32_32x32x16_bf16 v[100:115], v[20:23], v[156:159], v[140:155]
    v_add_u32 v160, 1024, v160
    v_add_u32 v161, 512, v161
    v_mfma_f32_32x32x16_bf16 v[124:139], v[64:67], v[120:123], v[124:139]
    s_setprio 0
    s_cbranch_vccnz L_ool_26
L_back_27:
    s_nop 6
    v_exp_f32 v100, v100
    v_exp_f32 v101, v101
    v_exp_f32 v102, v102
    v_cvt_pk_bf16_f32 v116, v100, v101
    v_exp_f32 v103, v103
    s_setprio 1
    v_exp_f32 v104, v104
    v_cvt_pk_bf16_f32 v117, v102, v103
    v_exp_f32 v105, v105
    v_exp_f32 v106, v106
    v_cvt_pk_bf16_f32 v118, v104, v105
    v_exp_f32 v107, v107
    v_exp_f32 v108, v108
    v_cvt_pk_bf16_f32 v119, v106, v107
    v_exp_f32 v109, v109
    v_exp_f32 v110, v110
    v_cvt_pk_bf16_f32 v120, v108, v109
    v_mfma_f32_32x32x16_bf16 v[124:139], v[68:71], v[116:119], v[124:139]
    v_exp_f32 v111, v111
    v_exp_f32 v112, v112
    v_cvt_pk_bf16_f32 v121, v110, v111
    v_exp_f32 v113, v113
    v_exp_f32 v114, v114
    v_exp_f32 v115, v115
    v_cvt_pk_bf16_f32 v122, v112, v113
    v_cvt_pk_bf16_f32 v123, v114, v115
    s_setprio 3
    v_mfma_f32_32x32x16_bf16 v[100:115], v[24:27], v[156:159], v[140:155]
    v_mfma_f32_32x32x16_bf16 v[124:139], v[72:75], v[120:123], v[124:139]
    s_setprio 0
    s_cbranch_vccnz L_ool_28
L_back_29:
    ds_read_b32 v167, v162
    s_and_b32 s47, s44, 3
    s_lshl_b32 s48, s47, 10
    s_add_u32 s48, s48, 131072
    s_lshl_b32 s47, s47, 14
    s_add_u32 s47, s47, s56
    s_add_u32 s48, s48, s59
    s_max_u32 s46, s44, 3
    s_sub_u32 s46, s46, 1
    s_cmp_lt_u32 s44, 2
    s_cselect_b32 s46, 1, s46
    v_exp_f32 v100, v100
    v_exp_f32 v101, v101
    v_exp_f32 v102, v102
    v_cvt_pk_bf16_f32 v116, v100, v101
    v_exp_f32 v103, v103
    s_setprio 1
    v_exp_f32 v104, v104
    v_cvt_pk_bf16_f32 v117, v102, v103
    v_exp_f32 v105, v105
    v_exp_f32 v106, v106
    v_cvt_pk_bf16_f32 v118, v104, v105
    v_exp_f32 v107, v107
    v_exp_f32 v108, v108
    v_cvt_pk_bf16_f32 v119, v106, v107
    v_exp_f32 v109, v109
    v_exp_f32 v110, v110
    v_cvt_pk_bf16_f32 v120, v108, v109
    v_mfma_f32_32x32x16_bf16 v[124:139], v[76:79], v[116:119], v[124:139]
    v_exp_f32 v111, v111
    v_exp_f32 v112, v112
    v_cvt_pk_bf16_f32 v121, v110, v111
    v_exp_f32 v113, v113
    v_exp_f32 v114, v114
    v_exp_f32 v115, v115
    v_cvt_pk_bf16_f32 v122, v112, v113
    v_cvt_pk_bf16_f32 v123, v114, v115
    s_setprio 3
    v_mfma_f32_32x32x16_bf16 v[100:115], v[28:31], v[156:159], v[140:155]
    v_lshl_add_u32 v165, v0, 3, s47
    v_add_u32 v166, s48, v3
    v_mfma_f32_32x32x16_bf16 v[124:139], v[80:83], v[120:123], v[124:139]
    s_setprio 0
    s_cbranch_vccnz L_ool_30
L_back_31:
    s_branch H_m0_skip
H_m0:
    s_setpc_b64 s[100:101]
H_m0_skip:
    s_nop 5
    v_exp_f32 v100, v100
    v_exp_f32 v101, v101
    v_exp_f32 v102, v102
    v_cvt_pk_bf16_f32 v116, v100, v101
    v_exp_f32 v103, v103
    s_setprio 1
    v_exp_f32 v104, v104
    v_cvt_pk_bf16_f32 v117, v102, v103
    v_exp_f32 v105, v105
    v_exp_f32 v106, v106
    v_cvt_pk_bf16_f32 v118, v104, v105
    v_exp_f32 v107, v107
    v_exp_f32 v108, v108
    v_cvt_pk_bf16_f32 v119, v106, v107
    v_exp_f32 v109, v109
    v_exp_f32 v110, v110
    v_cvt_pk_bf16_f32 v120, v108, v109
    v_mfma_f32_32x32x16_bf16 v[124:139], v[84:87], v[116:119], v[124:139]
    v_exp_f32 v111, v111
    v_exp_f32 v112, v112
    v_cvt_pk_bf16_f32 v121, v110, v111
    v_exp_f32 v113, v113
    v_exp_f32 v114, v114
    v_exp_f32 v115, v115
    v_cvt_pk_bf16_f32 v122, v112, v113
    v_cvt_pk_bf16_f32 v123, v114, v115
    s_setprio 3
    v_mfma_f32_32x32x16_bf16 v[100:115], v[32:35], v[156:159], v[140:155]
    s_waitcnt lgkmcnt(0)
    v_cmp_gt_u32_e64 s[52:53], s46, v167
    v_mfma_f32_32x32x16_bf16 v[124:139], v[88:91], v[120:123], v[124:139]
    s_setprio 0
    s_cbranch_vccnz L_ool_32
L_back_33:
    s_cmp_eq_u64 s[52:53], 0
    s_cbranch_scc0 L_ool_34
L_back_35:
    ds_read_b128 v[156:159], v160
    ds_read_b128 v[140:143], v161
    ds_read_b128 v[144:147], v161
    ds_read_b128 v[148:151], v161
    ds_read_b128 v[152:155], v161
    v_exp_f32 v100, v100
    v_exp_f32 v101, v101
    v_exp_f32 v102, v102
    v_cvt_pk_bf16_f32 v116, v100, v101
    v_exp_f32 v103, v103
    s_setprio 1
    v_exp_f32 v104, v104
    v_cvt_pk_bf16_f32 v117, v102, v103
    v_exp_f32 v105, v105
    v_exp_f32 v106, v106
    v_cvt_pk_bf16_f32 v118, v104, v105
    v_exp_f32 v107, v107
    v_exp_f32 v108, v108
    v_cvt_pk_bf16_f32 v119, v106, v107
    v_exp_f32 v109, v109
    v_exp_f32 v110, v110
    v_cvt_pk_bf16_f32 v120, v108, v109
    v_mfma_f32_32x32x16_bf16 v[124:139], v[92:95], v[116:119], v[124:139]
    v_exp_f32 v111, v111
    v_exp_f32 v112, v112
    v_cvt_pk_bf16_f32 v121, v110, v111
    v_exp_f32 v113, v113
    v_exp_f32 v114, v114
    v_exp_f32 v115, v115
    v_cvt_pk_bf16_f32 v122, v112, v113
    v_cvt_pk_bf16_f32 v123, v114, v115
    s_setprio 3
    s_waitcnt lgkmcnt(0)
    v_mfma_f32_32x32x16_bf16 v[100:115], v[4:7], v[156:159], v[140:155]
    v_mfma_f32_32x32x16_bf16 v[124:139], v[96:99], v[120:123], v[124:139]
    s_setprio 0
    s_add_u32 s44, s44, 1
    s_cmp_eq_u32 s44, 8
    s_cbranch_scc1 L_att_exit
    s_mov_b64 vcc, 0
    s_and_b32 s33, s44, s32
    s_nop 5
    ds_write2st64_b64 v165, v[124:125], v[126:127] offset0:0 offset1:1
    ds_write2st64_b64 v165, v[128:129], v[130:131] offset0:2 offset1:3
    ds_write_b32 v166, v132
    ds_write_b32 v163, v160 offset:16
L_att_body0:
    v_exp_f32 v100, v100
    v_exp_f32 v101, v101
    v_exp_f32 v102, v102
    v_cvt_pk_bf16_f32 v116, v100, v101
    v_exp_f32 v103, v103
    s_setprio 1
    v_exp_f32 v104, v104
    v_cvt_pk_bf16_f32 v117, v102, v103
    v_exp_f32 v105, v105
    v_exp_f32 v106, v106
    v_cvt_pk_bf16_f32 v118, v104, v105
    v_exp_f32 v107, v107
    v_exp_f32 v108, v108
    v_cvt_pk_bf16_f32 v119, v106, v107
    v_exp_f32 v109, v109
    v_exp_f32 v110, v110
    v_cvt_pk_bf16_f32 v120, v108, v109
    v_mfma_f32_32x32x16_bf16 v[124:139], v[36:39], v[116:119], 0
    v_exp_f32 v111, v111
    v_exp_f32 v112, v112
    v_cvt_pk_bf16_f32 v121, v110, v111
    v_exp_f32 v113, v113
    v_exp_f32 v114, v114
    v_exp_f32 v115, v115
    v_cvt_pk_bf16_f32 v122, v112, v113
    v_cvt_pk_bf16_f32 v123, v114, v115
    s_setprio 3
    v_mfma_f32_32x32x16_bf16 v[100:115], v[8:11], v[156:159], v[140:155]
    v_mfma_f32_32x32x16_bf16 v[124:139], v[40:43], v[120:123], v[124:139]
    s_setprio 0
    s_cbranch_vccnz L_ool_36
L_back_37:
    s_nop 7
    s_nop 0
    v_exp_f32 v100, v100
    v_exp_f32 v101, v101
    v_exp_f32 v102, v102
    v_cvt_pk_bf16_f32 v116, v100, v101
    v_exp_f32 v103, v103
    s_setprio 1
    v_exp_f32 v104, v104
    v_cvt_pk_bf16_f32 v117, v102, v103
    v_exp_f32 v105, v105
    v_exp_f32 v106, v106
    v_cvt_pk_bf16_f32 v118, v104, v105
    v_exp_f32 v107, v107
    v_exp_f32 v108, v108
    v_cvt_pk_bf16_f32 v119, v106, v107
    v_exp_f32 v109, v109
    v_exp_f32 v110, v110
    v_cvt_pk_bf16_f32 v120, v108, v109
    v_mfma_f32_32x32x16_bf16 v[124:139], v[44:47], v[116:119], v[124:139]
    v_exp_f32 v111, v111
    v_exp_f32 v112, v112
    v_cvt_pk_bf16_f32 v121, v110, v111
    v_exp_f32 v113, v113
    v_exp_f32 v114, v114
    v_exp_f32 v115, v115
    v_cvt_pk_bf16_f32 v122, v112, v113
    v_cvt_pk_bf16_f32 v123, v114, v115
    s_setprio 3
    v_mfma_f32_32x32x16_bf16 v[100:115], v[12:15], v[156:159], v[140:155]
    v_mfma_f32_32x32x16_bf16 v[124:139], v[48:51], v[120:123], v[124:139]
    s_setprio 0
    s_cmp_lg_u32 s33, 0
    s_cbranch_scc0 L_att_top0
    s_branch L_att_top1
H_t1:
    s_setpc_b64 s[100:101]
.p2align 6
L_att_top1:
    s_cbranch_vccnz L_ool_38
L_back_39:
    s_nop 7
    v_exp_f32 v100, v100
    v_exp_f32 v101, v101
    v_exp_f32 v102, v102
    v_cvt_pk_bf16_f32 v116, v100, v101
    v_exp_f32 v103, v103
    s_setprio 2
    v_exp_f32 v104, v104
    v_cvt_pk_bf16_f32 v117, v102, v103
    v_exp_f32 v105, v105
    v_exp_f32 v106, v106
    v_cvt_pk_bf16_f32 v118, v104, v105
    v_exp_f32 v107, v107
    v_exp_f32 v108, v108
    v_cvt_pk_bf16_f32 v119, v106, v107
    v_exp_f32 v109, v109
    v_exp_f32 v110, v110
    v_cvt_pk_bf16_f32 v120, v108, v109
    v_mfma_f32_32x32x16_bf16 v[124:139], v[52:55], v[116:119], v[124:139]
    v_exp_f32 v111, v111
    v_exp_f32 v112, v112
    v_cvt_pk_bf16_f32 v121, v110, v111
    v_exp_f32 v113, v113
    v_exp_f32 v114, v114
    v_exp_f32 v115, v115
    v_cvt_pk_bf16_f32 v122, v112, v113
    v_cvt_pk_bf16_f32 v123, v114, v115
    s_setprio 3
    v_mfma_f32_32x32x16_bf16 v[100:115], v[16:19], v[156:159], v[140:155]
    v_mfma_f32_32x32x16_bf16 v[124:139], v[56:59], v[120:123], v[124:139]
    s_setprio 1
    s_cbranch_vccnz L_ool_40
L_back_41:
    s_nop 7
    s_nop 0
    v_exp_f32 v100, v100
    v_exp_f32 v101, v101
    v_exp_f32 v102, v102
    v_cvt_pk_bf16_f32 v116, v100, v101
    v_exp_f32 v103, v103
    s_setprio 2
    v_exp_f32 v104, v104
    v_cvt_pk_bf16_f32 v117, v102, v103
    v_exp_f32 v105, v105
    v_exp_f32 v106, v106
    v_cvt_pk_bf16_f32 v118, v104, v105
    v_exp_f32 v107, v107
    v_exp_f32 v108, v108
    v_cvt_pk_bf16_f32 v119, v106, v107
    v_exp_f32 v109, v109
    v_exp_f32 v110, v110
    v_cvt_pk_bf16_f32 v120, v108, v109
    v_mfma_f32_32x32x16_bf16 v[124:139], v[60:63], v[116:119], v[124:139]
    v_exp_f32 v111, v111
    v_exp_f32 v112, v112
    v_cvt_pk_bf16_f32 v121, v110, v111
    v_exp_f32 v113, v113
    v_exp_f32 v114, v114
    v_exp_f32 v115, v115
    v_cvt_pk_bf16_f32 v122, v112, v113
    v_cvt_pk_bf16_f32 v123, v114, v115
    s_setprio 3
    v_mfma_f32_32x32x16_bf16 v[100:115], v[20:23], v[156:159], v[140:155]
    v_add_u32 v160, 1024, v160
    v_add_u32 v161, 512, v161
    v_mfma_f32_32x32x16_bf16 v[124:139], v[64:67], v[120:123], v[124:139]
    s_setprio 1
    s_cbranch_vccnz L_ool_42
L_back_43:
    s_nop 6
    v_exp_f32 v100, v100
    v_exp_f32 v101, v101
    v_exp_f32 v102, v102
    v_cvt_pk_bf16_f32 v116, v100, v101
    v_exp_f32 v103, v103
    s_setprio 2
    v_exp_f32 v104, v104
    v_cvt_pk_bf16_f32 v117, v102, v103
    v_exp_f32 v105, v105
    v_exp_f32 v106, v106
    v_cvt_pk_bf16_f32 v118, v104, v105
    v_exp_f32 v107, v107
    v_exp_f32 v108, v108
    v_cvt_pk_bf16_f32 v119, v106, v107
    v_exp_f32 v109, v109
    v_exp_f32 v110, v110
    v_cvt_pk_bf16_f32 v120, v108, v109
    v_mfma_f32_32x32x16_bf16 v[124:139], v[68:71], v[116:119], v[124:139]
    v_exp_f32 v111, v111
    v_exp_f32 v112, v112
    v_cvt_pk_bf16_f32 v121, v110, v111
    v_exp_f32 v113, v113
    v_exp_f32 v114, v114
    v_exp_f32 v115, v115
    v_cvt_pk_bf16_f32 v122, v112, v113
    v_cvt_pk_bf16_f32 v123, v114, v115
    s_setprio 3
    v_mfma_f32_32x32x16_bf16 v[100:115], v[24:27], v[156:159], v[140:155]
    v_mfma_f32_32x32x16_bf16 v[124:139], v[72:75], v[120:123], v[124:139]
    s_setprio 1
    s_cbranch_vccnz L_ool_44
L_back_45:
    ds_read_b32 v167, v162
    s_and_b32 s47, s44, 3
    s_lshl_b32 s48, s47, 10
    s_add_u32 s48, s48, 131072
    s_lshl_b32 s47, s47, 14
    s_add_u32 s47, s47, s56
    s_add_u32 s48, s48, s59
    s_max_u32 s46, s44, 3
    s_sub_u32 s46, s46, 1
    s_cmp_lt_u32 s44, 2
    s_cselect_b32 s46, 1, s46
    v_exp_f32 v100, v100
    v_exp_f32 v101, v101
    v_exp_f32 v102, v102
    v_cvt_pk_bf16_f32 v116, v100, v101
    v_exp_f32 v103, v103
    s_setprio 2
    v_exp_f32 v104, v104
    v_cvt_pk_bf16_f32 v117, v102, v103
    v_exp_f32 v105, v105
    v_exp_f32 v106, v106
    v_cvt_pk_bf16_f32 v118, v104, v105
    v_exp_f32 v107, v107
    v_exp_f32 v108, v108
    v_cvt_pk_bf16_f32 v119, v106, v107
    v_exp_f32 v109, v109
    v_exp_f32 v110, v110
    v_cvt_pk_bf16_f32 v120, v108, v109
    v_mfma_f32_32x32x16_bf16 v[124:139], v[76:79], v[116:119], v[124:139]
    v_exp_f32 v111, v111
    v_exp_f32 v112, v112
    v_cvt_pk_bf16_f32 v121, v110, v111
    v_exp_f32 v113, v113
    v_exp_f32 v114, v114
    v_exp_f32 v115, v115
    v_cvt_pk_bf16_f32 v122, v112, v113
    v_cvt_pk_bf16_f32 v123, v114, v115
    s_setprio 3
    v_mfma_f32_32x32x16_bf16 v[100:115], v[28:31], v[156:159], v[140:155]
    v_lshl_add_u32 v165, v0, 3, s47
    v_add_u32 v166, s48, v3
    v_mfma_f32_32x32x16_bf16 v[124:139], v[80:83], v[120:123], v[124:139]
    s_setprio 1
    s_cbranch_vccnz L_ool_46
L_back_47:
    s_branch H_m1_skip
H_m1:
    s_setpc_b64 s[100:101]
H_m1_skip:
    s_nop 5
    v_exp_f32 v100, v100
    v_exp_f32 v101, v101
    v_exp_f32 v102, v102
    v_cvt_pk_bf16_f32 v116, v100, v101
    v_exp_f32 v103, v103
    s_setprio 2
    v_exp_f32 v104, v104
    v_cvt_pk_bf16_f32 v117, v102, v103
    v_exp_f32 v105, v105
    v_exp_f32 v106, v106
    v_cvt_pk_bf16_f32 v118, v104, v105
    v_exp_f32 v107, v107
    v_exp_f32 v108, v108
    v_cvt_pk_bf16_f32 v119, v106, v107
    v_exp_f32 v109, v109
    v_exp_f32 v110, v110
    v_cvt_pk_bf16_f32 v120, v108, v109
    v_mfma_f32_32x32x16_bf16 v[124:139], v[84:87], v[116:119], v[124:139]
    v_exp_f32 v111, v111
    v_exp_f32 v112, v112
    v_cvt_pk_bf16_f32 v121, v110, v111
    v_exp_f32 v113, v113
    v_exp_f32 v114, v114
    v_exp_f32 v115, v115
    v_cvt_pk_bf16_f32 v122, v112, v113
    v_cvt_pk_bf16_f32 v123, v114, v115
    s_setprio 3
    v_mfma_f32_32x32x16_bf16 v[100:115], v[32:35], v[156:159], v[140:155]
    s_waitcnt lgkmcnt(0)
    v_cmp_gt_u32_e64 s[52:53], s46, v167
    v_mfma_f32_32x32x16_bf16 v[124:139], v[88:91], v[120:123], v[124:139]
    s_setprio 1
    s_cbranch_vccnz L_ool_48
L_back_49:
    s_cmp_eq_u64 s[52:53], 0
    s_cbranch_scc0 L_ool_50
L_back_51:
    ds_read_b128 v[156:159], v160
    ds_read_b128 v[140:143], v161
    ds_read_b128 v[144:147], v161
    ds_read_b128 v[148:151], v161
    ds_read_b128 v[152:155], v161
    v_exp_f32 v100, v100
    v_exp_f32 v101, v101
    v_exp_f32 v102, v102
    v_cvt_pk_bf16_f32 v116, v100, v101
    v_exp_f32 v103, v103
    s_setprio 2
    v_exp_f32 v104, v104
    v_cvt_pk_bf16_f32 v117, v102, v103
    v_exp_f32 v105, v105
    v_exp_f32 v106, v106
    v_cvt_pk_bf16_f32 v118, v104, v105
    v_exp_f32 v107, v107
    v_exp_f32 v108, v108
    v_cvt_pk_bf16_f32 v119, v106, v107
    v_exp_f32 v109, v109
    v_exp_f32 v110, v110
    v_cvt_pk_bf16_f32 v120, v108, v109
    v_mfma_f32_32x32x16_bf16 v[124:139], v[92:95], v[116:119], v[124:139]
    v_exp_f32 v111, v111
    v_exp_f32 v112, v112
    v_cvt_pk_bf16_f32 v121, v110, v111
    v_exp_f32 v113, v113
    v_exp_f32 v114, v114
    v_exp_f32 v115, v115
    v_cvt_pk_bf16_f32 v122, v112, v113
    v_cvt_pk_bf16_f32 v123, v114, v115
    s_setprio 3
    s_waitcnt lgkmcnt(0)
    v_mfma_f32_32x32x16_bf16 v[100:115], v[4:7], v[156:159], v[140:155]
    v_mfma_f32_32x32x16_bf16 v[124:139], v[96:99], v[120:123], v[124:139]
    s_setprio 1
    s_add_u32 s44, s44, 1
    s_cmp_eq_u32 s44, 8
    s_cbranch_scc1 L_att_exit
    s_mov_b64 vcc, 0
    s_and_b32 s33, s44, s32
    s_nop 5
    ds_write2st64_b64 v165, v[124:125], v[126:127] offset0:0 offset1:1
    ds_write2st64_b64 v165, v[128:129], v[130:131] offset0:2 offset1:3
    ds_write_b32 v166, v132
    ds_write_b32 v163, v160 offset:16
L_att_body1:
    v_exp_f32 v100, v100
    v_exp_f32 v101, v101
    v_exp_f32 v102, v102
    v_cvt_pk_bf16_f32 v116, v100, v101
    v_exp_f32 v103, v103
    s_setprio 2
    v_exp_f32 v104, v104
    v_cvt_pk_bf16_f32 v117, v102, v103
    v_exp_f32 v105, v105
    v_exp_f32 v106, v106
    v_cvt_pk_bf16_f32 v118, v104, v105
    v_exp_f32 v107, v107
    v_exp_f32 v108, v108
    v_cvt_pk_bf16_f32 v119, v106, v107
    v_exp_f32 v109, v109
    v_exp_f32 v110, v110
    v_cvt_pk_bf16_f32 v120, v108, v109
    v_mfma_f32_32x32x16_bf16 v[124:139], v[36:39], v[116:119], 0
    v_exp_f32 v111, v111
    v_exp_f32 v112, v112
    v_cvt_pk_bf16_f32 v121, v110, v111
    v_exp_f32 v113, v113
    v_exp_f32 v114, v114
    v_exp_f32 v115, v115
    v_cvt_pk_bf16_f32 v122, v112, v113
    v_cvt_pk_bf16_f32 v123, v114, v115
    s_setprio 3
    v_mfma_f32_32x32x16_bf16 v[100:115], v[8:11], v[156:159], v[140:155]
    v_mfma_f32_32x32x16_bf16 v[124:139], v[40:43], v[120:123], v[124:139]
    s_setprio 1
    s_cbranch_vccnz L_ool_52
L_back_53:
    s_nop 7
    s_nop 0
    v_exp_f32 v100, v100
    v_exp_f32 v101, v101
    v_exp_f32 v102, v102
    v_cvt_pk_bf16_f32 v116, v100, v101
    v_exp_f32 v103, v103
    s_setprio 2
    v_exp_f32 v104, v104
    v_cvt_pk_bf16_f32 v117, v102, v103
    v_exp_f32 v105, v105
    v_exp_f32 v106, v106
    v_cvt_pk_bf16_f32 v118, v104, v105
    v_exp_f32 v107, v107
    v_exp_f32 v108, v108
    v_cvt_pk_bf16_f32 v119, v106, v107
    v_exp_f32 v109, v109
    v_exp_f32 v110, v110
    v_cvt_pk_bf16_f32 v120, v108, v109
    v_mfma_f32_32x32x16_bf16 v[124:139], v[44:47], v[116:119], v[124:139]
    v_exp_f32 v111, v111
    v_exp_f32 v112, v112
    v_cvt_pk_bf16_f32 v121, v110, v111
    v_exp_f32 v113, v113
    v_exp_f32 v114, v114
    v_exp_f32 v115, v115
    v_cvt_pk_bf16_f32 v122, v112, v113
    v_cvt_pk_bf16_f32 v123, v114, v115
    s_setprio 3
    v_mfma_f32_32x32x16_bf16 v[100:115], v[12:15], v[156:159], v[140:155]
    v_mfma_f32_32x32x16_bf16 v[124:139], v[48:51], v[120:123], v[124:139]
    s_setprio 1
    s_cmp_lg_u32 s33, 0
    s_cbranch_scc1 L_att_top1
    s_branch L_att_top0
H_ex:
    s_setpc_b64 s[100:101]
L_att_exit:
    s_nop 7
    ds_write2st64_b64 v165, v[124:125], v[126:127] offset0:0 offset1:1
    ds_write2st64_b64 v165, v[128:129], v[130:131] offset0:2 offset1:3
    ds_write_b32 v166, v132
    ds_write_b32 v163, v160 offset:16
    s_waitcnt lgkmcnt(0)
    s_barrier
    v_and_b32 v165, 3, v0
    v_lshlrev_b32 v165, 2, v165
    v_add_u32 v165, 161856, v165
    s_barrier
    s_barrier
    ds_read_b32 v165, v165
    s_waitcnt lgkmcnt(0)
    v_cmp_ne_u32 vcc, 0, v165
    s_cmp_eq_u64 vcc, 0
    s_cbranch_scc1 L_end
    v_lshlrev_b32 v160, 4, v0
    v_add_u32 v160, 147456, v160
    v_and_b32 v161, 31, v0
    v_lshlrev_b32 v161, 4, v161
    v_add_u32 v161, 155648, v161
    s_lshl_b32 s46, s3, 2
    s_add_u32 s46, s46, 161776
    v_mov_b32 v163, s46
    v_and_b32 v162, 3, v0
    v_lshlrev_b32 v162, 2, v162
    v_add_u32 v162, 161840, v162
    s_mov_b32 s44, 0
    v_and_b32 v3, 31, v0
    v_lshlrev_b32 v3, 2, v3
    s_lshl_b32 s56, s3, 11
    s_lshl_b32 s59, s3, 7
    v_mov_b32 v166, 0xff800000
    s_lshl_b32 s46, s3, 7
    s_add_u32 s46, s46, 135168
    v_and_b32 v167, 31, v0
    v_lshl_add_u32 v141, v167, 2, s46
    ds_write_b32 v141, v166
    v_lshlrev_b32 v167, 2, v167
    v_add_u32 v167, 135168, v167
    s_waitcnt lgkmcnt(0)
    s_barrier
    s_cmp_lg_u32 s3, 0
    s_cbranch_scc1 L_nz_54
    v_and_b32 v165, 31, v0
    v_and_b32 v166, 28, v0
    v_cmp_eq_u32 vcc, 12, v166
    v_lshlrev_b32 v165, 2, v165
    v_add_u32 v165, 161792, v165
    v_cndmask_b32_e64 v166, 0, 2, vcc
    ds_write_b32 v165, v166
L_nz_54:
L_fb_loop:
    ds_read_b128 v[156:159], v160
    s_waitcnt lgkmcnt(0)
    v_mfma_f32_32x32x16_bf16 v[100:115], v[4:7], v[156:159], 0
    s_nop 7
    s_nop 3
    v_max3_f32 v166, v100, v101, v102
    v_max3_f32 v166, v166, v103, v104
    v_max3_f32 v166, v166, v105, v106
    v_max3_f32 v166, v166, v107, v108
    v_max3_f32 v166, v166, v109, v110
    v_max3_f32 v166, v166, v111, v112
    v_max3_f32 v166, v166, v113, v114
    v_max_f32 v166, v166, v115
    v_mfma_f32_32x32x16_bf16 v[100:115], v[8:11], v[156:159], 0
    s_nop 7
    s_nop 3
    v_max3_f32 v166, v166, v100, v101
    v_max3_f32 v166, v166, v102, v103
    v_max3_f32 v166, v166, v104, v105
    v_max3_f32 v166, v166, v106, v107
    v_max3_f32 v166, v166, v108, v109
    v_max3_f32 v166, v166, v110, v111
    v_max3_f32 v166, v166, v112, v113
    v_max3_f32 v166, v166, v114, v115
    v_mfma_f32_32x32x16_bf16 v[100:115], v[12:15], v[156:159], 0
    s_nop 7
    s_nop 3
    v_max3_f32 v166, v166, v100, v101
    v_max3_f32 v166, v166, v102, v103
    v_max3_f32 v166, v166, v104, v105
    v_max3_f32 v166, v166, v106, v107
    v_max3_f32 v166, v166, v108, v109
    v_max3_f32 v166, v166, v110, v111
    v_max3_f32 v166, v166, v112, v113
    v_max3_f32 v166, v166, v114, v115
    v_mfma_f32_32x32x16_bf16 v[100:115], v[16:19], v[156:159], 0
    s_nop 7
    s_nop 3
    v_max3_f32 v166, v166, v100, v101
    v_max3_f32 v166, v166, v102, v103
    v_max3_f32 v166, v166, v104, v105
    v_max3_f32 v166, v166, v106, v107
    v_max3_f32 v166, v166, v108, v109
    v_max3_f32 v166, v166, v110, v111
    v_max3_f32 v166, v166, v112, v113
    v_max3_f32 v166, v166, v114, v115
    v_mfma_f32_32x32x16_bf16 v[100:115], v[20:23], v[156:159], 0
    s_nop 7
    s_nop 3
    v_max3_f32 v166, v166, v100, v101
    v_max3_f32 v166, v166, v102, v103
    v_max3_f32 v166, v166, v104, v105
    v_max3_f32 v166, v166, v106, v107
    v_max3_f32 v166, v166, v108, v109
    v_max3_f32 v166, v166, v110, v111
    v_max3_f32 v166, v166, v112, v113
    v_max3_f32 v166, v166, v114, v115
    v_mfma_f32_32x32x16_bf16 v[100:115], v[24:27], v[156:159], 0
    s_nop 7
    s_nop 3
    v_max3_f32 v166, v166, v100, v101
    v_max3_f32 v166, v166, v102, v103
    v_max3_f32 v166, v166, v104, v105
    v_max3_f32 v166, v166, v106, v107
    v_max3_f32 v166, v166, v108, v109
    v_max3_f32 v166, v166, v110, v111
    v_max3_f32 v166, v166, v112, v113
    v_max3_f32 v166, v166, v114, v115
    v_mfma_f32_32x32x16_bf16 v[100:115], v[28:31], v[156:159], 0
    s_nop 7
    s_nop 3
    v_max3_f32 v166, v166, v100, v101
    v_max3_f32 v166, v166, v102, v103
    v_max3_f32 v166, v166, v104, v105
    v_max3_f32 v166, v166, v106, v107
    v_max3_f32 v166, v166, v108, v109
    v_max3_f32 v166, v166, v110, v111
    v_max3_f32 v166, v166, v112, v113
    v_max3_f32 v166, v166, v114, v115
    v_mfma_f32_32x32x16_bf16 v[100:115], v[32:35], v[156:159], 0
    s_nop 7
    s_nop 3
    v_max3_f32 v166, v166, v100, v101
    v_max3_f32 v166, v166, v102, v103
    v_max3_f32 v166, v166, v104, v105
    v_max3_f32 v166, v166, v106, v107
    v_max3_f32 v166, v166, v108, v109
    v_max3_f32 v166, v166, v110, v111
    v_max3_f32 v166, v166, v112, v113
    v_max3_f32 v166, v166, v114, v115
    v_mov_b32 v140, v166
    s_nop 1
    v_permlane32_swap_b32 v166, v140
    s_nop 1
    v_max_f32 v166, v166, v140
    ds_max_f32 v167, v166
    v_add_u32 v167, 128, v167
    v_add_u32 v160, 1024, v160
    s_add_u32 s44, s44, 1
    s_cmp_lt_u32 s44, 8
    s_cbranch_scc1 L_fb_loop
    s_waitcnt lgkmcnt(0)
    s_barrier
    ds_read_b32 v166, v141
    v_lshlrev_b32 v160, 4, v0
    v_add_u32 v160, 147456, v160
    v_and_b32 v161, 31, v0
    v_lshlrev_b32 v161, 4, v161
    v_add_u32 v161, 155648, v161
    s_lshl_b32 s46, s3, 2
    s_add_u32 s46, s46, 161776
    v_mov_b32 v163, s46
    v_and_b32 v162, 3, v0
    v_lshlrev_b32 v162, 2, v162
    v_add_u32 v162, 161840, v162
    s_mov_b32 s44, 0
    v_and_b32 v3, 31, v0
    v_lshlrev_b32 v3, 2, v3
    s_lshl_b32 s56, s3, 11
    s_lshl_b32 s59, s3, 7
    s_waitcnt lgkmcnt(0)
    v_sub_f32 v120, 0, v166
    v_mov_b32 v121, v120
    v_mov_b32 v122, v120
    v_mov_b32 v123, v120
    s_lshl_b32 s46, s3, 9
    v_add_u32 v165, s46, v161
    ds_write_b128 v165, v[120:123]
    s_mov_b64 vcc, 0
    s_waitcnt lgkmcnt(0)
    s_barrier
    ds_read_b128 v[156:159], v160
    ds_read_b128 v[140:143], v161
    ds_read_b128 v[144:147], v161
    ds_read_b128 v[148:151], v161
    ds_read_b128 v[152:155], v161
    s_branch L_att_go
H_ool:
    s_setpc_b64 s[100:101]
L_ool_22:
    s_add_u32 s51, s50, s58
    s_mov_b64 exec, s[30:31]
    buffer_load_dwordx4 v[68:71], v1, s[4:7], s51 offen sc1
    buffer_load_dwordx4 v[72:75], v1, s[4:7], s51 offen offset:256 sc1
    s_mov_b64 exec, -1
    s_add_u32 s50, s50, 1024
    s_and_b32 s50, s50, 8191
    s_add_u32 s51, s50, s57
    buffer_load_dwordx4 v[24:27], v1, s[4:7], s51 offen sc1
    s_waitcnt vmcnt(6)
    s_branch L_back_23
L_ool_24:
    s_add_u32 s51, s50, s58
    s_mov_b64 exec, s[30:31]
    buffer_load_dwordx4 v[76:79], v1, s[4:7], s51 offen sc1
    buffer_load_dwordx4 v[80:83], v1, s[4:7], s51 offen offset:256 sc1
    s_mov_b64 exec, -1
    s_add_u32 s50, s50, 1024
    s_and_b32 s50, s50, 8191
    s_add_u32 s51, s50, s57
    buffer_load_dwordx4 v[28:31], v1, s[4:7], s51 offen sc1
    s_waitcnt vmcnt(6)
    s_branch L_back_25
L_ool_26:
    s_add_u32 s51, s50, s58
    s_mov_b64 exec, s[30:31]
    buffer_load_dwordx4 v[84:87], v1, s[4:7], s51 offen sc1
    buffer_load_dwordx4 v[88:91], v1, s[4:7], s51 offen offset:256 sc1
    s_mov_b64 exec, -1
    s_add_u32 s50, s50, 1024
    s_and_b32 s50, s50, 8191
    s_add_u32 s51, s50, s57
    buffer_load_dwordx4 v[32:35], v1, s[4:7], s51 offen sc1
    s_waitcnt vmcnt(6)
    s_branch L_back_27
L_ool_28:
    s_add_u32 s51, s50, s58
    s_mov_b64 exec, s[30:31]
    buffer_load_dwordx4 v[92:95], v1, s[4:7], s51 offen sc1
    buffer_load_dwordx4 v[96:99], v1, s[4:7], s51 offen offset:256 sc1
    s_mov_b64 exec, -1
    s_waitcnt vmcnt(5)
    s_branch L_back_29
L_ool_30:
    s_waitcnt vmcnt(2)
    ds_write_b32 v163, v162 offset:112
    s_branch L_back_31
L_ool_32:
    s_waitcnt vmcnt(0)
    s_branch L_back_33
L_ool_34:
    s_mov_b32 s54, 0x40000
L_bp_55:
    ds_read_b32 v167, v162
    s_waitcnt lgkmcnt(0)
    v_cmp_gt_u32_e64 s[52:53], s46, v167
    s_cmp_eq_u64 s[52:53], 0
    s_cbranch_scc1 L_bpok_56
    s_sleep 1
    s_sub_u32 s54, s54, 1
    s_cbranch_scc0 L_bp_55
L_bpok_56:
    s_branch L_back_35
L_ool_36:
    s_add_u32 s51, s50, s58
    s_mov_b64 exec, s[30:31]
    buffer_load_dwordx4 v[60:63], v1, s[4:7], s51 offen sc1
    buffer_load_dwordx4 v[64:67], v1, s[4:7], s51 offen offset:256 sc1
    s_mov_b64 exec, -1
    s_add_u32 s50, s50, 1024
    s_and_b32 s50, s50, 8191
    s_add_u32 s51, s50, s57
    buffer_load_dwordx4 v[20:23], v1, s[4:7], s51 offen sc1
    s_waitcnt vmcnt(6)
    s_branch L_back_37
L_ool_38:
    s_add_u32 s51, s50, s58
    s_mov_b64 exec, s[30:31]
    buffer_load_dwordx4 v[68:71], v1, s[4:7], s51 offen sc1
    buffer_load_dwordx4 v[72:75], v1, s[4:7], s51 offen offset:256 sc1
    s_mov_b64 exec, -1
    s_add_u32 s50, s50, 1024
    s_and_b32 s50, s50, 8191
    s_add_u32 s51, s50, s57
    buffer_load_dwordx4 v[24:27], v1, s[4:7], s51 offen sc1
    s_waitcnt vmcnt(6)
    s_branch L_back_39
L_ool_40:
    s_add_u32 s51, s50, s58
    s_mov_b64 exec, s[30:31]
    buffer_load_dwordx4 v[76:79], v1, s[4:7], s51 offen sc1
    buffer_load_dwordx4 v[80:83], v1, s[4:7], s51 offen offset:256 sc1
    s_mov_b64 exec, -1
    s_add_u32 s50, s50, 1024
    s_and_b32 s50, s50, 8191
    s_add_u32 s51, s50, s57
    buffer_load_dwordx4 v[28:31], v1, s[4:7], s51 offen sc1
    s_waitcnt vmcnt(6)
    s_branch L_back_41
L_ool_42:
    s_add_u32 s51, s50, s58
    s_mov_b64 exec, s[30:31]
    buffer_load_dwordx4 v[84:87], v1, s[4:7], s51 offen sc1
    buffer_load_dwordx4 v[88:91], v1, s[4:7], s51 offen offset:256 sc1
    s_mov_b64 exec, -1
    s_add_u32 s50, s50, 1024
    s_and_b32 s50, s50, 8191
    s_add_u32 s51, s50, s57
    buffer_load_dwordx4 v[32:35], v1, s[4:7], s51 offen sc1
    s_waitcnt vmcnt(6)
    s_branch L_back_43
L_ool_44:
    s_add_u32 s51, s50, s58
    s_mov_b64 exec, s[30:31]
    buffer_load_dwordx4 v[92:95], v1, s[4:7], s51 offen sc1
    buffer_load_dwordx4 v[96:99], v1, s[4:7], s51 offen offset:256 sc1
    s_mov_b64 exec, -1
    s_waitcnt vmcnt(5)
    s_branch L_back_45
L_ool_46:
    s_waitcnt vmcnt(2)
    ds_write_b32 v163, v162 offset:112
    s_branch L_back_47
L_ool_48:
    s_waitcnt vmcnt(0)
    s_branch L_back_49
L_ool_50:
    s_mov_b32 s54, 0x40000
L_bp_57:
    ds_read_b32 v167, v162
    s_waitcnt lgkmcnt(0)
    v_cmp_gt_u32_e64 s[52:53], s46, v167
    s_cmp_eq_u64 s[52:53], 0
    s_cbranch_scc1 L_bpok_58
    s_sleep 1
    s_sub_u32 s54, s54, 1
    s_cbranch_scc0 L_bp_57
L_bpok_58:
    s_branch L_back_51
L_ool_52:
    s_add_u32 s51, s50, s58
    s_mov_b64 exec, s[30:31]
    buffer_load_dwordx4 v[60:63], v1, s[4:7], s51 offen sc1
    buffer_load_dwordx4 v[64:67], v1, s[4:7], s51 offen offset:256 sc1
    s_mov_b64 exec, -1
    s_add_u32 s50, s50, 1024
    s_and_b32 s50, s50, 8191
    s_add_u32 s51, s50, s57
    buffer_load_dwordx4 v[20:23], v1, s[4:7], s51 offen sc1
    s_waitcnt vmcnt(6)
    s_branch L_back_53
L_aux:
    s_sub_u32 s45, s3, 8
    v_lshlrev_b32 v156, 4, v0
    s_mov_b32 s61, 0
    s_and_b32 s90, s38, 3
    s_lshl_b32 s90, s90, 3
    s_add_u32 s90, s90, s37
    s_and_b32 s91, s45, 1
    s_lshr_b32 s60, s45, 1
    v_lshrrev_b32 v1, 3, v0
    s_lshl_b32 s46, s45, 4
    s_add_u32 s46, s46, 0
    v_add_u32 v163, s46, v1
    v_bfe_u32 v3, v163, 1, 3
    v_and_b32 v161, 7, v0
    v_xor_b32 v3, v3, v161
    v_lshlrev_b32 v3, 4, v3
    v_lshl_add_u32 v134, v1, 10, v3
    v_and_b32 v161, 0x13, v163
    v_bfe_u32 v162, v163, 2, 1
    v_lshl_add_u32 v161, v162, 3, v161
    v_bfe_u32 v162, v163, 3, 1
    v_lshl_add_u32 v161, v162, 2, v161
    v_lshl_add_u32 v3, v161, 16, v3
    v_lshrrev_b32 v162, 5, v163
    v_lshl_add_u32 v132, v162, 10, v3
    v_lshrrev_b32 v1, 3, v0
    s_lshl_b32 s46, s45, 4
    s_add_u32 s46, s46, 8
    v_add_u32 v163, s46, v1
    v_bfe_u32 v3, v163, 1, 3
    v_and_b32 v161, 7, v0
    v_xor_b32 v3, v3, v161
    v_lshlrev_b32 v3, 4, v3
    v_lshl_add_u32 v135, v1, 10, v3
    v_and_b32 v161, 0x13, v163
    v_bfe_u32 v162, v163, 2, 1
    v_lshl_add_u32 v161, v162, 3, v161
    v_bfe_u32 v162, v163, 3, 1
    v_lshl_add_u32 v161, v162, 2, v161
    v_lshl_add_u32 v3, v161, 16, v3
    v_lshrrev_b32 v162, 5, v163
    v_lshl_add_u32 v133, v162, 10, v3
    s_waitcnt lgkmcnt(0)
    s_load_dword s43, s[88:89], 0
    s_mov_b32 s4, s88
    s_mov_b32 s5, s89
    s_mov_b32 s6, 0x680000
    s_mov_b32 s7, 0x00020000
    s_mov_b32 s32, s74
    s_mov_b32 s33, s75
    s_mov_b32 s34, 0x200000
    s_mov_b32 s35, 0x00020000
    s_mov_b32 s24, s84
    s_mov_b32 s25, s85
    s_mov_b32 s26, 0x400000
    s_mov_b32 s27, 0x00020000
    s_cmp_eq_u32 s91, 0
    s_cselect_b32 s12, s80, s82
    s_cselect_b32 s13, s81, s83
    s_mov_b32 s14, 0x80000
    s_mov_b32 s15, 0x00020000
    s_lshl_b32 s50, s40, 11
    s_lshl_b32 s51, s41, 5
    s_lshl_b32 s46, s60, 3
    s_add_u32 s51, s51, s46
    s_add_u32 s51, s51, 1
    s_lshl_b32 s51, s51, 10
    s_lshl_b32 s52, s45, 11
    s_lshl_b32 s46, s41, 2
    s_add_u32 s46, s46, s45
    s_cmp_eq_u32 s46, 31
    s_cselect_b32 s53, 0x00ffffff, -1
    v_bfe_u32 v1, v0, 3, 1
    v_mul_u32_u24 v1, 0xaaaa, v1
    v_add_u32 v157, 0x4444, v1
    v_and_b32 v1, 31, v0
    s_lshl_b32 s46, s91, 5
    v_add_u32 v1, s46, v1
    v_bfe_u32 v161, v1, 1, 3
    v_lshrrev_b32 v3, 5, v0
    v_xor_b32 v161, v161, v3
    v_lshlrev_b32 v1, 7, v1
    v_add_u32 v1, 65536, v1
    v_xor_b32 v3, 0, v161
    v_lshl_add_u32 v148, v3, 4, v1
    v_xor_b32 v3, 2, v161
    v_lshl_add_u32 v149, v3, 4, v1
    v_xor_b32 v3, 4, v161
    v_lshl_add_u32 v150, v3, 4, v1
    v_xor_b32 v3, 6, v161
    v_lshl_add_u32 v151, v3, 4, v1
    v_and_b32 v1, 31, v0
    s_lshl_b32 s46, s60, 5
    v_add_u32 v1, s46, v1
    v_bfe_u32 v161, v1, 1, 3
    v_lshrrev_b32 v3, 5, v0
    v_xor_b32 v161, v161, v3
    v_lshlrev_b32 v1, 7, v1
    v_add_u32 v1, 73728, v1
    v_xor_b32 v3, 0, v161
    v_lshl_add_u32 v152, v3, 4, v1
    v_xor_b32 v3, 2, v161
    v_lshl_add_u32 v153, v3, 4, v1
    v_xor_b32 v3, 4, v161
    v_lshl_add_u32 v154, v3, 4, v1
    v_xor_b32 v3, 6, v161
    v_lshl_add_u32 v155, v3, 4, v1
    s_mov_b32 s44, 0
    v_and_b32 v122, 31, v0
    s_lshl_b32 s46, s60, 5
    v_add_u32 v122, s46, v122
    v_bfe_u32 v123, v122, 1, 3
    v_lshrrev_b32 v124, 5, v0
    v_xor_b32 v123, v123, v124
    v_lshlrev_b32 v122, 7, v122
    v_xor_b32 v125, 0, v123
    v_lshl_add_u32 v116, v125, 4, v122
    v_xor_b32 v125, 2, v123
    v_lshl_add_u32 v117, v125, 4, v122
    v_xor_b32 v125, 4, v123
    v_lshl_add_u32 v118, v125, 4, v122
    v_xor_b32 v125, 6, v123
    v_lshl_add_u32 v119, v125, 4, v122
    v_bfe_u32 v122, v0, 2, 2
    v_lshrrev_b32 v123, 1, v122
    v_xor_b32 v123, s91, v123
    v_lshl_add_u32 v122, v124, 3, v122
    v_lshlrev_b32 v122, 7, v122
    v_lshl_add_u32 v122, v123, 6, v122
    v_bfe_u32 v123, v0, 4, 1
    v_lshl_add_u32 v122, v123, 5, v122
    v_and_b32 v123, 3, v0
    v_lshl_add_u32 v122, v123, 3, v122
    v_add_u32 v120, 65536, v122
    v_and_b32 v122, 7, v0
    v_lshlrev_b32 v122, 4, v122
    v_lshl_add_u32 v122, v124, 9, v122
    v_bfe_u32 v123, v0, 3, 2
    v_lshl_add_u32 v122, v123, 10, v122
    s_lshl_b32 s46, s91, 8
    s_lshl_b32 s47, s60, 12
    s_add_u32 s46, s46, s47
    s_add_u32 s46, s46, 139264
    v_add_u32 v121, s46, v122
    s_mov_b32 s54, 0x3eb8aa3b
    s_lshl_b32 s46, s45, 9
    v_lshl_add_u32 v158, v0, 3, s46
    v_and_b32 v1, 31, v0
    v_lshrrev_b32 v3, 5, v0
    v_lshlrev_b32 v159, 2, v1
    v_bfe_u32 v161, v0, 3, 2
    v_and_b32 v1, 7, v0
    v_lshl_add_u32 v3, v3, 3, v1
    v_lshl_add_u32 v3, v161, 4, v3
    s_lshl_b32 s46, s45, 2
    s_add_u32 s46, s46, 159744
    v_lshl_add_u32 v164, v3, 4, s46
    v_and_b32 v3, 3, v0
    v_lshlrev_b32 v3, 2, v3
    v_add_u32 v165, 161840, v3
    v_lshlrev_b32 v1, 2, v1
    v_add_u32 v160, 161792, v1
    v_mov_b32 v167, 1
    s_lshl_b32 s46, s45, 2
    s_add_u32 s46, s46, 161840
    v_mov_b32 v166, s46
    v_mov_b32 v4, 0
    v_mov_b32 v5, 0
    v_mov_b32 v6, 0
    v_mov_b32 v7, 0
    v_mov_b32 v8, 0
    v_mov_b32 v9, 0
    v_mov_b32 v10, 0
    v_mov_b32 v11, 0
    v_mov_b32 v12, 0
    v_mov_b32 v13, 0
    v_mov_b32 v14, 0
    v_mov_b32 v15, 0
    v_mov_b32 v16, 0
    v_mov_b32 v17, 0
    v_mov_b32 v18, 0
    v_mov_b32 v19, 0
    v_mov_b32 v20, 0
    v_mov_b32 v21, 0
    v_mov_b32 v22, 0
    v_mov_b32 v23, 0
    v_mov_b32 v24, 0
    v_mov_b32 v25, 0
    v_mov_b32 v26, 0
    v_mov_b32 v27, 0
    v_mov_b32 v28, 0
    v_mov_b32 v29, 0
    v_mov_b32 v30, 0
    v_mov_b32 v31, 0
    v_mov_b32 v32, 0
    v_mov_b32 v33, 0
    v_mov_b32 v34, 0
    v_mov_b32 v35, 0
    s_waitcnt lgkmcnt(0)
    s_andn2_b32 s43, s43, 3
    s_add_u32 s43, s43, 4
    v_lshlrev_b32 v48, 8, v0
    v_add_u32 v48, 4096, v48
    s_setprio 2
    s_cmp_lg_u32 s45, 0
    s_cbranch_scc1 L_hopn_60
    s_call_b64 s[100:101], H_f1
    s_call_b64 s[100:101], H_f2
    s_call_b64 s[100:101], H_f3
    s_branch L_hopd_59
L_hopn_60:
    s_cmp_lg_u32 s45, 1
    s_cbranch_scc1 L_hopn_61
    s_call_b64 s[100:101], H_f4
    s_call_b64 s[100:101], H_f5
    s_call_b64 s[100:101], H_op
    s_branch L_hopd_59
L_hopn_61:
    s_cmp_lg_u32 s45, 2
    s_cbranch_scc1 L_hopn_62
    s_call_b64 s[100:101], H_hk
    s_call_b64 s[100:101], H_h2
    s_call_b64 s[100:101], H_s7
    s_branch L_hopd_59
L_hopn_62:
    s_cmp_lg_u32 s45, 3
    s_cbranch_scc1 L_hopn_63
    s_call_b64 s[100:101], H_q1
    s_call_b64 s[100:101], H_q2
    s_branch L_hopd_59
L_hopn_63:
L_hopd_59:
    s_barrier
    s_barrier
    ds_read_b64_tr_b16 v[52:53], v120 offset:0
    ds_read_b64_tr_b16 v[54:55], v120 offset:512
    ds_read_b128 v[72:75], v116 offset:0
    ds_read_b64_tr_b16 v[56:57], v120 offset:2048
    ds_read_b64_tr_b16 v[58:59], v120 offset:2560
    ds_read_b128 v[76:79], v117 offset:0
    ds_read_b64_tr_b16 v[60:61], v120 offset:4096
    ds_read_b64_tr_b16 v[62:63], v120 offset:4608
    ds_read_b128 v[80:83], v118 offset:0
    ds_read_b64_tr_b16 v[64:65], v120 offset:6144
    ds_read_b64_tr_b16 v[66:67], v120 offset:6656
    ds_read_b128 v[84:87], v119 offset:0
    s_waitcnt lgkmcnt(9)
    v_mfma_f32_32x32x16_bf16 v[100:115], v[52:55], v[72:75], 0
    ds_read_b64_tr_b16 v[68:69], v120 offset:8192
    ds_read_b64_tr_b16 v[70:71], v120 offset:8704
    ds_read_b128 v[88:91], v116 offset:8192
    s_waitcnt lgkmcnt(9)
    v_mfma_f32_32x32x16_bf16 v[100:115], v[56:59], v[76:79], v[100:115]
    ds_read_b64_tr_b16 v[52:53], v120 offset:10240
    ds_read_b64_tr_b16 v[54:55], v120 offset:10752
    ds_read_b128 v[72:75], v117 offset:8192
    s_waitcnt lgkmcnt(9)
    v_mfma_f32_32x32x16_bf16 v[100:115], v[60:63], v[80:83], v[100:115]
    ds_read_b64_tr_b16 v[56:57], v120 offset:12288
    ds_read_b64_tr_b16 v[58:59], v120 offset:12800
    ds_read_b128 v[76:79], v118 offset:8192
    s_waitcnt lgkmcnt(9)
    v_mfma_f32_32x32x16_bf16 v[100:115], v[64:67], v[84:87], v[100:115]
    ds_read_b64_tr_b16 v[60:61], v120 offset:14336
    ds_read_b64_tr_b16 v[62:63], v120 offset:14848
    ds_read_b128 v[80:83], v119 offset:8192
    s_waitcnt lgkmcnt(9)
    v_mfma_f32_32x32x16_bf16 v[100:115], v[68:71], v[88:91], v[100:115]
    s_waitcnt lgkmcnt(6)
    v_mfma_f32_32x32x16_bf16 v[100:115], v[52:55], v[72:75], v[100:115]
    s_waitcnt lgkmcnt(3)
    v_mfma_f32_32x32x16_bf16 v[100:115], v[56:59], v[76:79], v[100:115]
    s_waitcnt lgkmcnt(0)
    v_mfma_f32_32x32x16_bf16 v[100:115], v[60:63], v[80:83], v[100:115]
    s_barrier
    s_branch H_q1_skip
H_q1:
    s_setpc_b64 s[100:101]
H_q1_skip:
    ds_read_b64_tr_b16 v[64:65], v120 offset:16384
    ds_read_b64_tr_b16 v[66:67], v120 offset:16896
    ds_read_b128 v[84:87], v116 offset:16384
    ds_read_b64_tr_b16 v[68:69], v120 offset:18432
    ds_read_b64_tr_b16 v[70:71], v120 offset:18944
    ds_read_b128 v[88:91], v117 offset:16384
    ds_read_b64_tr_b16 v[52:53], v120 offset:20480
    ds_read_b64_tr_b16 v[54:55], v120 offset:20992
    ds_read_b128 v[72:75], v118 offset:16384
    ds_read_b64_tr_b16 v[56:57], v120 offset:22528
    ds_read_b64_tr_b16 v[58:59], v120 offset:23040
    ds_read_b128 v[76:79], v119 offset:16384
    s_waitcnt lgkmcnt(9)
    v_mfma_f32_32x32x16_bf16 v[100:115], v[64:67], v[84:87], v[100:115]
    ds_read_b64_tr_b16 v[60:61], v120 offset:24576
    ds_read_b64_tr_b16 v[62:63], v120 offset:25088
    ds_read_b128 v[80:83], v116 offset:24576
    s_waitcnt lgkmcnt(9)
    v_mfma_f32_32x32x16_bf16 v[100:115], v[68:71], v[88:91], v[100:115]
    ds_read_b64_tr_b16 v[64:65], v120 offset:26624
    ds_read_b64_tr_b16 v[66:67], v120 offset:27136
    ds_read_b128 v[84:87], v117 offset:24576
    s_waitcnt lgkmcnt(9)
    v_mfma_f32_32x32x16_bf16 v[100:115], v[52:55], v[72:75], v[100:115]
    ds_read_b64_tr_b16 v[68:69], v120 offset:28672
    ds_read_b64_tr_b16 v[70:71], v120 offset:29184
    ds_read_b128 v[88:91], v118 offset:24576
    s_waitcnt lgkmcnt(9)
    v_mfma_f32_32x32x16_bf16 v[100:115], v[56:59], v[76:79], v[100:115]
    ds_read_b64_tr_b16 v[52:53], v120 offset:30720
    ds_read_b64_tr_b16 v[54:55], v120 offset:31232
    ds_read_b128 v[72:75], v119 offset:24576
    s_waitcnt lgkmcnt(9)
    v_mfma_f32_32x32x16_bf16 v[100:115], v[60:63], v[80:83], v[100:115]
    s_waitcnt lgkmcnt(6)
    v_mfma_f32_32x32x16_bf16 v[100:115], v[64:67], v[84:87], v[100:115]
    s_waitcnt lgkmcnt(3)
    v_mfma_f32_32x32x16_bf16 v[100:115], v[68:71], v[88:91], v[100:115]
    s_waitcnt lgkmcnt(0)
    v_mfma_f32_32x32x16_bf16 v[100:115], v[52:55], v[72:75], v[100:115]
    s_barrier
    s_mov_b64 exec, 0x3
    buffer_load_dword v49, v48, s[4:7], 0 offen sc1
    s_mov_b64 exec, -1
    ds_read_b64_tr_b16 v[56:57], v120 offset:32768
    ds_read_b64_tr_b16 v[58:59], v120 offset:33280
    ds_read_b128 v[76:79], v116 offset:32768
    ds_read_b64_tr_b16 v[60:61], v120 offset:34816
    ds_read_b64_tr_b16 v[62:63], v120 offset:35328
    ds_read_b128 v[80:83], v117 offset:32768
    ds_read_b64_tr_b16 v[64:65], v120 offset:36864
    ds_read_b64_tr_b16 v[66:67], v120 offset:37376
    ds_read_b128 v[84:87], v118 offset:32768
    ds_read_b64_tr_b16 v[68:69], v120 offset:38912
    ds_read_b64_tr_b16 v[70:71], v120 offset:39424
    ds_read_b128 v[88:91], v119 offset:32768
    s_waitcnt lgkmcnt(9)
    v_mfma_f32_32x32x16_bf16 v[100:115], v[56:59], v[76:79], v[100:115]
    ds_read_b64_tr_b16 v[52:53], v120 offset:40960
    ds_read_b64_tr_b16 v[54:55], v120 offset:41472
    ds_read_b128 v[72:75], v116 offset:40960
    s_waitcnt lgkmcnt(9)
    v_mfma_f32_32x32x16_bf16 v[100:115], v[60:63], v[80:83], v[100:115]
    ds_read_b64_tr_b16 v[56:57], v120 offset:43008
    ds_read_b64_tr_b16 v[58:59], v120 offset:43520
    ds_read_b128 v[76:79], v117 offset:40960
    s_waitcnt lgkmcnt(9)
    v_mfma_f32_32x32x16_bf16 v[100:115], v[64:67], v[84:87], v[100:115]
    ds_read_b64_tr_b16 v[60:61], v120 offset:45056
    ds_read_b64_tr_b16 v[62:63], v120 offset:45568
    ds_read_b128 v[80:83], v118 offset:40960
    s_waitcnt lgkmcnt(9)
    v_mfma_f32_32x32x16_bf16 v[100:115], v[68:71], v[88:91], v[100:115]
    ds_read_b64_tr_b16 v[64:65], v120 offset:47104
    ds_read_b64_tr_b16 v[66:67], v120 offset:47616
    ds_read_b128 v[84:87], v119 offset:40960
    s_waitcnt lgkmcnt(9)
    v_mfma_f32_32x32x16_bf16 v[100:115], v[52:55], v[72:75], v[100:115]
    s_waitcnt lgkmcnt(6)
    v_mfma_f32_32x32x16_bf16 v[100:115], v[56:59], v[76:79], v[100:115]
    s_waitcnt lgkmcnt(3)
    v_mfma_f32_32x32x16_bf16 v[100:115], v[60:63], v[80:83], v[100:115]
    s_waitcnt lgkmcnt(0)
    v_mfma_f32_32x32x16_bf16 v[100:115], v[64:67], v[84:87], v[100:115]
    s_barrier
    s_branch H_q2_skip
H_q2:
    s_setpc_b64 s[100:101]
H_q2_skip:
    ds_read_b64_tr_b16 v[68:69], v120 offset:49152
    ds_read_b64_tr_b16 v[70:71], v120 offset:49664
    ds_read_b128 v[88:91], v116 offset:49152
    ds_read_b64_tr_b16 v[52:53], v120 offset:51200
    ds_read_b64_tr_b16 v[54:55], v120 offset:51712
    ds_read_b128 v[72:75], v117 offset:49152
    ds_read_b64_tr_b16 v[56:57], v120 offset:53248
    ds_read_b64_tr_b16 v[58:59], v120 offset:53760
    ds_read_b128 v[76:79], v118 offset:49152
    ds_read_b64_tr_b16 v[60:61], v120 offset:55296
    ds_read_b64_tr_b16 v[62:63], v120 offset:55808
    ds_read_b128 v[80:83], v119 offset:49152
    s_waitcnt lgkmcnt(9)
    v_mfma_f32_32x32x16_bf16 v[100:115], v[68:71], v[88:91], v[100:115]
    ds_read_b64_tr_b16 v[64:65], v120 offset:57344
    ds_read_b64_tr_b16 v[66:67], v120 offset:57856
    ds_read_b128 v[84:87], v116 offset:57344
    s_waitcnt lgkmcnt(9)
    v_mfma_f32_32x32x16_bf16 v[100:115], v[52:55], v[72:75], v[100:115]
    ds_read_b64_tr_b16 v[68:69], v120 offset:59392
    ds_read_b64_tr_b16 v[70:71], v120 offset:59904
    ds_read_b128 v[88:91], v117 offset:57344
    s_waitcnt lgkmcnt(9)
    v_mfma_f32_32x32x16_bf16 v[100:115], v[56:59], v[76:79], v[100:115]
    ds_read_b64_tr_b16 v[52:53], v120 offset:61440
    ds_read_b64_tr_b16 v[54:55], v120 offset:61952
    ds_read_b128 v[72:75], v118 offset:57344
    s_waitcnt lgkmcnt(9)
    v_mfma_f32_32x32x16_bf16 v[100:115], v[60:63], v[80:83], v[100:115]
    ds_read_b64_tr_b16 v[56:57], v120 offset:63488
    ds_read_b64_tr_b16 v[58:59], v120 offset:64000
    ds_read_b128 v[76:79], v119 offset:57344
    s_waitcnt lgkmcnt(9)
    v_mfma_f32_32x32x16_bf16 v[100:115], v[64:67], v[84:87], v[100:115]
    s_waitcnt lgkmcnt(6)
    v_mfma_f32_32x32x16_bf16 v[100:115], v[68:71], v[88:91], v[100:115]
    s_waitcnt lgkmcnt(3)
    v_mfma_f32_32x32x16_bf16 v[100:115], v[52:55], v[72:75], v[100:115]
    s_waitcnt lgkmcnt(0)
    v_mfma_f32_32x32x16_bf16 v[100:115], v[56:59], v[76:79], v[100:115]
    s_nop 7
    s_nop 3
    v_mul_f32 v100, s54, v100
    v_mul_f32 v101, s54, v101
    v_mul_f32 v102, s54, v102
    v_mul_f32 v103, s54, v103
    v_mul_f32 v104, s54, v104
    v_mul_f32 v105, s54, v105
    v_mul_f32 v106, s54, v106
    v_mul_f32 v107, s54, v107
    v_mul_f32 v108, s54, v108
    v_mul_f32 v109, s54, v109
    v_mul_f32 v110, s54, v110
    v_mul_f32 v111, s54, v111
    v_mul_f32 v112, s54, v112
    v_mul_f32 v113, s54, v113
    v_mul_f32 v114, s54, v114
    v_mul_f32 v115, s54, v115
    v_cvt_pk_bf16_f32 v52, v100, v101
    v_cvt_pk_bf16_f32 v53, v102, v103
    v_cvt_pk_bf16_f32 v54, v104, v105
    v_cvt_pk_bf16_f32 v55, v106, v107
    v_cvt_pk_bf16_f32 v56, v108, v109
    v_cvt_pk_bf16_f32 v57, v110, v111
    v_cvt_pk_bf16_f32 v58, v112, v113
    v_cvt_pk_bf16_f32 v59, v114, v115
    ds_write_b128 v121, v[52:55]
    ds_write_b128 v121, v[56:59] offset:128
    v_mov_b32 v122, 161832
    v_mov_b32 v123, 1
    s_mov_b64 exec, 1
    ds_add_u32 v122, v123
    s_mov_b64 exec, -1
    s_mov_b32 s63, 0
    s_setprio 3
    v_mov_b32 v50, 0
    s_lshr_b32 s46, s41, 1
    s_lshl_b32 s46, s46, 4
    s_add_u32 s46, s46, s45
    s_cmp_lg_u32 s46, 19
    s_cbranch_scc1 L_nowp_64
    s_mov_b32 s8, s72
    s_mov_b32 s9, s73
    s_mov_b32 s10, 0x80000
    s_mov_b32 s11, 0x00020000
    s_sub_u32 s48, s41, 2
    s_lshl_b32 s48, s48, 5
    s_add_u32 s48, s48, s40
    s_lshr_b32 s49, s48, 1
    s_and_b32 s47, s48, 1
    s_lshl_b32 s47, s47, 1
    v_lshrrev_b32 v1, 5, v0
    v_add_u32 v1, s47, v1
    v_bfe_u32 v50, v0, 4, 1
    v_lshlrev_b32 v50, 13, v50
    v_lshl_add_u32 v50, v1, 8, v50
    v_and_b32 v3, 15, v0
    v_lshl_add_u32 v50, v3, 4, v50
    s_lshl_b32 s54, s49, 14
    buffer_load_dwordx4 v[52:55], v50, s[8:11], s54 offen offset:0
    buffer_load_dwordx4 v[56:59], v50, s[8:11], s54 offen offset:1024
    buffer_load_dwordx4 v[60:63], v50, s[8:11], s54 offen offset:2048
    buffer_load_dwordx4 v[64:67], v50, s[8:11], s54 offen offset:3072
    s_add_u32 s54, s54, 4096
    buffer_load_dwordx4 v[68:71], v50, s[8:11], s54 offen offset:0
    buffer_load_dwordx4 v[72:75], v50, s[8:11], s54 offen offset:1024
    buffer_load_dwordx4 v[76:79], v50, s[8:11], s54 offen offset:2048
    buffer_load_dwordx4 v[80:83], v50, s[8:11], s54 offen offset:3072
    s_lshr_b32 s54, s49, 2
    s_lshl_b32 s54, s54, 16
    s_bfe_u32 s46, s49, 0x10001
    s_lshl_b32 s46, s46, 10
    s_add_u32 s54, s54, s46
    s_and_b32 s46, s49, 1
    s_lshl_b32 s46, s46, 9
    s_add_u32 s54, s54, s46
    s_add_u32 s54, s54, 524288
    v_and_b32 v50, 31, v0
    v_lshlrev_b32 v50, 4, v50
    v_lshl_add_u32 v50, v1, 14, v50
    s_lshl_b32 s61, s48, 7
    s_add_u32 s61, s61, 69632
    s_mov_b32 s46, 0x05040100
    s_mov_b32 s47, 0x07060302
    s_waitcnt vmcnt(0)
    v_perm_b32 v100, v56, v52, s46
    v_perm_b32 v101, v72, v68, s46
    v_perm_b32 v102, v64, v60, s46
    v_perm_b32 v103, v80, v76, s46
    v_perm_b32 v104, v56, v52, s47
    v_perm_b32 v105, v72, v68, s47
    v_perm_b32 v106, v64, v60, s47
    v_perm_b32 v107, v80, v76, s47
    v_perm_b32 v108, v57, v53, s46
    v_perm_b32 v109, v73, v69, s46
    v_perm_b32 v110, v65, v61, s46
    v_perm_b32 v111, v81, v77, s46
    v_perm_b32 v112, v57, v53, s47
    v_perm_b32 v113, v73, v69, s47
    v_perm_b32 v114, v65, v61, s47
    v_perm_b32 v115, v81, v77, s47
    v_perm_b32 v116, v58, v54, s46
    v_perm_b32 v117, v74, v70, s46
    v_perm_b32 v118, v66, v62, s46
    v_perm_b32 v119, v82, v78, s46
    v_perm_b32 v120, v58, v54, s47
    v_perm_b32 v121, v74, v70, s47
    v_perm_b32 v122, v66, v62, s47
    v_perm_b32 v123, v82, v78, s47
    v_perm_b32 v124, v59, v55, s46
    v_perm_b32 v125, v75, v71, s46
    v_perm_b32 v126, v67, v63, s46
    v_perm_b32 v127, v83, v79, s46
    v_perm_b32 v128, v59, v55, s47
    v_perm_b32 v129, v75, v71, s47
    v_perm_b32 v130, v67, v63, s47
    v_perm_b32 v131, v83, v79, s47
L_nowp_64:
    s_mov_b64 exec, 0x3
    s_waitcnt vmcnt(0)
    s_mov_b32 s55, 0x20000
L_gp_65:
    v_cmp_ne_u32 vcc, s43, v49
    s_cmp_eq_u64 vcc, 0
    s_cbranch_scc1 L_gpd_66
    s_sleep 4
    buffer_load_dword v49, v48, s[4:7], 0 offen sc1
    s_waitcnt vmcnt(0)
    s_sub_u32 s55, s55, 1
    s_cbranch_scc0 L_gp_65
L_gpd_66:
    s_mov_b64 exec, -1
    s_mov_b32 s46, 131072
    buffer_load_dwordx4 v[44:47], v156, s[4:7], s46 offen sc1
    v_mov_b32 v163, 161832
    s_mov_b32 s55, 0x40000
L_poll_67:
    ds_read_b32 v161, v163
    s_waitcnt lgkmcnt(0)
    v_readfirstlane_b32 s46, v161
    s_cmp_ge_u32 s46, 4
    s_cbranch_scc1 L_done_68
    s_sleep 1
    s_sub_u32 s55, s55, 1
    s_cbranch_scc0 L_poll_67
L_done_68:
    s_branch H_f1_skip
H_f1:
    s_setpc_b64 s[100:101]
H_f1_skip:
    s_cmp_lg_u32 s45, 0
    s_cbranch_scc1 L_nou_69
    s_mov_b32 s48, 1
    s_mov_b32 s49, 2
    s_sub_u32 s46, s41, s48
    s_and_b32 s46, s46, 7
    s_lshl_b32 s47, s46, 10
    s_add_u32 s47, s47, 139264
    v_add_u32 v1, s47, v156
    ds_read_b32 v100, v1 offset:0
    ds_read_b32 v102, v1 offset:4
    ds_read_b32 v104, v1 offset:8
    ds_read_b32 v106, v1 offset:12
    s_lshl_b32 s47, s40, 3
    s_add_u32 s46, s46, s47
    s_lshl_b32 s47, s48, 8
    s_add_u32 s46, s46, s47
    s_lshl_b32 s46, s46, 11
    s_add_u32 s46, s46, 524288
    v_mov_b32 v101, s43
    v_mov_b32 v103, s43
    v_mov_b32 v105, s43
    v_mov_b32 v107, s43
    s_waitcnt lgkmcnt(0)
    buffer_store_dwordx4 v[100:103], v156, s[4:7], s46 offen sc1
    buffer_store_dwordx4 v[104:107], v156, s[4:7], s46 offen offset:1024 sc1
    s_sub_u32 s46, s41, s49
    s_and_b32 s46, s46, 7
    s_lshl_b32 s47, s46, 10
    s_add_u32 s47, s47, 139264
    v_add_u32 v1, s47, v156
    ds_read_b32 v116, v1 offset:0
    ds_read_b32 v118, v1 offset:4
    ds_read_b32 v120, v1 offset:8
    ds_read_b32 v122, v1 offset:12
    s_lshl_b32 s47, s40, 3
    s_add_u32 s46, s46, s47
    s_lshl_b32 s47, s49, 8
    s_add_u32 s46, s46, s47
    s_lshl_b32 s46, s46, 11
    s_add_u32 s46, s46, 524288
    v_mov_b32 v117, s43
    v_mov_b32 v119, s43
    v_mov_b32 v121, s43
    v_mov_b32 v123, s43
    s_waitcnt lgkmcnt(0)
    buffer_store_dwordx4 v[116:119], v156, s[4:7], s46 offen sc1
    buffer_store_dwordx4 v[120:123], v156, s[4:7], s46 offen offset:1024 sc1
    s_sleep 30
    s_lshl_b32 s46, s48, 8
    s_add_u32 s46, s46, s36
    s_lshl_b32 s46, s46, 11
    s_add_u32 s56, s46, 524288
    s_lshl_b32 s46, s49, 8
    s_add_u32 s46, s46, s36
    s_lshl_b32 s46, s46, 11
    s_add_u32 s57, s46, 524288
    s_mov_b32 s55, 0x20000
L_qtry_71:
    buffer_load_dwordx4 v[116:119], v156, s[4:7], s56 offen offset:0 sc1
    buffer_load_dwordx4 v[120:123], v156, s[4:7], s56 offen offset:1024 sc1
    buffer_load_dwordx4 v[124:127], v156, s[4:7], s57 offen offset:0 sc1
    buffer_load_dwordx4 v[128:131], v156, s[4:7], s57 offen offset:1024 sc1
    s_waitcnt vmcnt(0)
L_qchk_73:
    v_xor_b32 v1, s43, v117
    v_bitop3_b32 v1, v1, v119, s43 bitop3:0xf6
    v_bitop3_b32 v1, v1, v121, s43 bitop3:0xf6
    v_bitop3_b32 v1, v1, v123, s43 bitop3:0xf6
    v_bitop3_b32 v1, v1, v125, s43 bitop3:0xf6
    v_bitop3_b32 v1, v1, v127, s43 bitop3:0xf6
    v_bitop3_b32 v1, v1, v129, s43 bitop3:0xf6
    v_bitop3_b32 v1, v1, v131, s43 bitop3:0xf6
    v_cmp_ne_u32 vcc, 0, v1
    s_cmp_eq_u64 vcc, 0
    s_cbranch_scc1 L_qok_72
    s_sleep 6
    s_sub_u32 s55, s55, 1
    s_cbranch_scc0 L_qtry_71
L_qok_72:
    v_mov_b32 v117, v118
    v_mov_b32 v118, v120
    v_mov_b32 v119, v122
    v_mov_b32 v125, v126
    v_mov_b32 v126, v128
    v_mov_b32 v127, v130
    s_nop 0
    v_mfma_f32_32x32x16_bf16 v[52:67], v[44:47], v[116:119], 0
    v_mfma_f32_32x32x16_bf16 v[68:83], v[44:47], v[124:127], 0
    s_lshl_b32 s46, s48, 10
    s_add_u32 s46, s46, 147456
    v_add_u32 v1, s46, v156
    ds_write_b128 v1, v[116:119]
    s_lshl_b32 s46, s48, 9
    s_add_u32 s46, s46, 155648
    v_and_b32 v1, 31, v0
    v_lshl_add_u32 v84, v1, 4, s46
    s_lshl_b32 s46, s49, 10
    s_add_u32 s46, s46, 147456
    v_add_u32 v1, s46, v156
    ds_write_b128 v1, v[124:127]
    s_lshl_b32 s46, s49, 9
    s_add_u32 s46, s46, 155648
    v_and_b32 v1, 31, v0
    v_lshl_add_u32 v85, v1, 4, s46
    v_max3_f32 v161, v52, v53, v54
    v_max3_f32 v161, v161, v55, v56
    v_max3_f32 v161, v161, v57, v58
    v_max3_f32 v161, v161, v59, v60
    v_max3_f32 v161, v161, v61, v62
    v_max3_f32 v161, v161, v63, v64
    v_max3_f32 v161, v161, v65, v66
    v_max_f32 v161, v161, v67
    v_max3_f32 v162, v68, v69, v70
    v_max3_f32 v162, v162, v71, v72
    v_max3_f32 v162, v162, v73, v74
    v_max3_f32 v162, v162, v75, v76
    v_max3_f32 v162, v162, v77, v78
    v_max3_f32 v162, v162, v79, v80
    v_max3_f32 v162, v162, v81, v82
    v_max_f32 v162, v162, v83
    s_nop 1
    v_permlane32_swap_b32 v161, v162
    s_nop 1
    v_max_f32 v161, v161, v162
    v_sub_f32 v52, 0xc2d00000, v161
    s_mov_b32 exec_lo, 0
    v_mov_b32 v84, v85
    s_mov_b32 exec_lo, -1
    v_mov_b32 v53, v52
    v_mov_b32 v54, v52
    v_mov_b32 v55, v52
    ds_write_b128 v84, v[52:55]
L_nou_69:
    s_cmp_lg_u32 s45, 1
    s_cbranch_scc1 L_nocp_70
    s_lshl_b32 s46, s41, 10
    s_add_u32 s46, s46, 139264
    v_add_u32 v1, s46, v156
    ds_read_b128 v[36:39], v1
    v_add_u32 v1, 147456, v156
    s_waitcnt lgkmcnt(0)
    ds_write_b128 v1, v[36:39]
L_nocp_70:
    s_mov_b64 exec, 1
    ds_add_u32 v166, v167
    s_mov_b64 exec, -1
    s_cmp_eq_u32 s53, -1
    s_cbranch_scc1 L_noones_74
    v_mov_b32 v116, 0x3f803f80
    v_mov_b32 v117, 0x3f803f80
    v_mov_b32 v118, 0x3f803f80
    v_mov_b32 v119, 0x3f803f80
    v_bfe_u32 v1, v0, 3, 2
    v_lshlrev_b32 v1, 14, v1
    v_and_b32 v3, 7, v0
    v_lshl_add_u32 v1, v3, 4, v1
    v_add_u32 v1, 81792, v1
    ds_write_b128 v1, v[116:119]
L_noones_74:
    v_mov_b32 v163, 161824
    v_lshlrev_b32 v48, 7, v0
    v_add_u32 v48, 69632, v48
    s_cmp_lg_u32 s45, 1
    s_cbranch_scc1 L_no_75
    s_add_u32 s92, s88, 0x200000
    s_addc_u32 s93, s89, 0
    s_load_dword s95, s[92:93], 0
    s_load_dword s95, s[74:75], 0
L_no_75:
    s_cmp_lg_u32 s45, 2
    s_cbranch_scc1 L_no_76
    s_add_u32 s92, s88, 0x400000
    s_addc_u32 s93, s89, 0
    s_load_dword s95, s[92:93], 0
    s_load_dword s95, s[80:81], 0
L_no_76:
    s_cmp_lg_u32 s45, 3
    s_cbranch_scc1 L_no_77
    s_add_u32 s92, s88, 0x600000
    s_addc_u32 s93, s89, 0
    s_load_dword s95, s[92:93], 0
    s_load_dword s95, s[82:83], 0
L_no_77:
    s_mov_b32 s55, 0x40000
L_kvw_78:
    ds_read_b32 v161, v160 offset:96
    s_waitcnt lgkmcnt(0)
    v_cmp_eq_u32 vcc, 0, v161
    s_cmp_eq_u64 vcc, 0
    s_cbranch_scc1 L_kvwd_79
    s_sleep 4
    s_sub_u32 s55, s55, 1
    s_cbranch_scc0 L_kvw_78
L_kvwd_79:
    s_cmp_eq_u32 s61, 0
    s_cbranch_scc1 L_nowo3_80
    buffer_store_dwordx4 v[100:103], v50, s[4:7], s54 offen offset:0 sc1
    buffer_store_dwordx4 v[104:107], v50, s[4:7], s54 offen offset:2048 sc1
    s_add_u32 s54, s54, 4096
    buffer_store_dwordx4 v[108:111], v50, s[4:7], s54 offen offset:0 sc1
    buffer_store_dwordx4 v[112:115], v50, s[4:7], s54 offen offset:2048 sc1
    s_add_u32 s54, s54, 4096
    buffer_store_dwordx4 v[116:119], v50, s[4:7], s54 offen offset:0 sc1
    buffer_store_dwordx4 v[120:123], v50, s[4:7], s54 offen offset:2048 sc1
    s_add_u32 s54, s54, 4096
    buffer_store_dwordx4 v[124:127], v50, s[4:7], s54 offen offset:0 sc1
    buffer_store_dwordx4 v[128:131], v50, s[4:7], s54 offen offset:2048 sc1
L_nowo3_80:
    s_branch H_f2_skip
H_f2:
    s_setpc_b64 s[100:101]
H_f2_skip:
    s_add_u32 s46, s42, 0
    s_and_b32 s46, s46, 7
    s_lshl_b32 s46, s46, 7
    s_add_u32 s47, s46, s50
    s_add_u32 m0, s52, 65536
    s_add_u32 s46, s46, s51
    buffer_load_dwordx4 v132, s[32:35], s47 offen lds
    s_add_u32 m0, s52, 66560
    s_nop 0
    buffer_load_dwordx4 v133, s[32:35], s47 offen lds
    s_add_u32 m0, s52, 73728
    s_nop 0
    buffer_load_dwordx4 v134, s[12:15], s46 offen lds
    s_add_u32 m0, s52, 74752
    s_add_u32 s46, s46, 16384
    s_mov_b32 exec_hi, s53
    buffer_load_dwordx4 v135, s[12:15], s46 offen lds
    s_mov_b32 exec_hi, -1
    s_cmp_eq_u32 s61, 0
    s_cbranch_scc1 L_nowo2_81
    s_waitcnt vmcnt(4)
    v_mov_b32 v1, 0
    v_mov_b32 v3, s43
    s_mov_b64 exec, 1
    buffer_store_dword v3, v1, s[4:7], s61 offen sc1
    s_mov_b64 exec, -1
L_nowo2_81:
    s_add_u32 s46, s42, 1
    s_and_b32 s46, s46, 7
    s_lshl_b32 s46, s46, 7
    s_add_u32 s47, s46, s50
    s_add_u32 m0, s52, 81920
    s_add_u32 s46, s46, s51
    buffer_load_dwordx4 v132, s[32:35], s47 offen lds
    s_add_u32 m0, s52, 82944
    s_nop 0
    buffer_load_dwordx4 v133, s[32:35], s47 offen lds
    s_add_u32 m0, s52, 90112
    s_nop 0
    buffer_load_dwordx4 v134, s[12:15], s46 offen lds
    s_add_u32 m0, s52, 91136
    s_add_u32 s46, s46, 16384
    s_mov_b32 exec_hi, s53
    buffer_load_dwordx4 v135, s[12:15], s46 offen lds
    s_mov_b32 exec_hi, -1
    s_add_u32 s46, s42, 2
    s_and_b32 s46, s46, 7
    s_lshl_b32 s46, s46, 7
    s_add_u32 s47, s46, s50
    s_add_u32 m0, s52, 98304
    s_add_u32 s46, s46, s51
    buffer_load_dwordx4 v132, s[32:35], s47 offen lds
    s_add_u32 m0, s52, 99328
    s_nop 0
    buffer_load_dwordx4 v133, s[32:35], s47 offen lds
    s_add_u32 m0, s52, 106496
    s_nop 0
    buffer_load_dwordx4 v134, s[12:15], s46 offen lds
    s_add_u32 m0, s52, 107520
    s_add_u32 s46, s46, 16384
    s_mov_b32 exec_hi, s53
    buffer_load_dwordx4 v135, s[12:15], s46 offen lds
    s_mov_b32 exec_hi, -1
    s_add_u32 s46, s42, 3
    s_and_b32 s46, s46, 7
    s_lshl_b32 s46, s46, 7
    s_add_u32 s47, s46, s50
    s_add_u32 m0, s52, 114688
    s_add_u32 s46, s46, s51
    buffer_load_dwordx4 v132, s[32:35], s47 offen lds
    s_add_u32 m0, s52, 115712
    s_nop 0
    buffer_load_dwordx4 v133, s[32:35], s47 offen lds
    s_add_u32 m0, s52, 122880
    s_nop 0
    buffer_load_dwordx4 v134, s[12:15], s46 offen lds
    s_add_u32 m0, s52, 123904
    s_add_u32 s46, s46, 16384
    s_mov_b32 exec_hi, s53
    buffer_load_dwordx4 v135, s[12:15], s46 offen lds
    s_mov_b32 exec_hi, -1
    s_cmp_eq_u32 s45, 0
    s_cbranch_scc1 L_nosl_82
    s_add_u32 s48, s45, 2
    s_sub_u32 s46, s41, s48
    s_and_b32 s46, s46, 7
    s_lshl_b32 s47, s46, 10
    s_add_u32 s47, s47, 139264
    v_add_u32 v1, s47, v156
    ds_read_b32 v116, v1 offset:0
    ds_read_b32 v118, v1 offset:4
    ds_read_b32 v120, v1 offset:8
    ds_read_b32 v122, v1 offset:12
    s_lshl_b32 s47, s40, 3
    s_add_u32 s46, s46, s47
    s_lshl_b32 s47, s48, 8
    s_add_u32 s46, s46, s47
    s_lshl_b32 s46, s46, 11
    s_add_u32 s46, s46, 524288
    v_mov_b32 v117, s43
    v_mov_b32 v119, s43
    v_mov_b32 v121, s43
    v_mov_b32 v123, s43
    s_waitcnt lgkmcnt(0)
    buffer_store_dwordx4 v[116:119], v156, s[4:7], s46 offen sc1
    buffer_store_dwordx4 v[120:123], v156, s[4:7], s46 offen offset:1024 sc1
    s_waitcnt vmcnt(2)
    s_cmp_eq_u32 s45, 3
    s_cbranch_scc1 L_sent_83
    s_add_u32 s48, s45, 5
    s_sub_u32 s46, s41, s48
    s_and_b32 s46, s46, 7
    s_lshl_b32 s47, s46, 10
    s_add_u32 s47, s47, 139264
    v_add_u32 v1, s47, v156
    ds_read_b32 v100, v1 offset:0
    ds_read_b32 v102, v1 offset:4
    ds_read_b32 v104, v1 offset:8
    ds_read_b32 v106, v1 offset:12
    s_lshl_b32 s47, s40, 3
    s_add_u32 s46, s46, s47
    s_lshl_b32 s47, s48, 8
    s_add_u32 s46, s46, s47
    s_lshl_b32 s46, s46, 11
    s_add_u32 s46, s46, 524288
    v_mov_b32 v101, s43
    v_mov_b32 v103, s43
    v_mov_b32 v105, s43
    v_mov_b32 v107, s43
    s_waitcnt lgkmcnt(0)
    buffer_store_dwordx4 v[100:103], v156, s[4:7], s46 offen sc1
    buffer_store_dwordx4 v[104:107], v156, s[4:7], s46 offen offset:1024 sc1
    s_branch L_sent_83
L_nosl_82:
    s_waitcnt vmcnt(0)
L_sent_83:
    s_mov_b64 exec, 1
    ds_add_u32 v163, v167
    s_mov_b64 exec, -1
    s_mov_b32 s55, 0x40000
L_poll_84:
    ds_read_b32 v161, v163
    s_waitcnt lgkmcnt(0)
    v_readfirstlane_b32 s46, v161
    s_cmp_ge_u32 s46, 4
    s_cbranch_scc1 L_done_85
    s_sleep 1
    s_sub_u32 s55, s55, 1
    s_cbranch_scc0 L_poll_84
L_done_85:
    s_branch H_f3_skip
H_f3:
    s_setpc_b64 s[100:101]
H_f3_skip:
    ds_read_b128 v[52:55], v148 offset:0
    ds_read_b128 v[56:59], v152 offset:0
    ds_read_b128 v[60:63], v149 offset:0
    ds_read_b128 v[64:67], v153 offset:0
    ds_read_b128 v[68:71], v150 offset:0
    ds_read_b128 v[72:75], v154 offset:0
    ds_read_b128 v[76:79], v151 offset:0
    ds_read_b128 v[80:83], v155 offset:0
    s_waitcnt lgkmcnt(6)
    v_mfma_f32_32x32x16_bf16 v[100:115], v[52:55], v[56:59], 0
    s_sleep 1
    ds_read_b128 v[84:87], v148 offset:16384
    ds_read_b128 v[88:91], v152 offset:16384
    s_waitcnt lgkmcnt(6)
    v_mfma_f32_32x32x16_bf16 v[100:115], v[60:63], v[64:67], v[100:115]
    s_sleep 1
    ds_read_b128 v[52:55], v149 offset:16384
    ds_read_b128 v[56:59], v153 offset:16384
    s_waitcnt lgkmcnt(6)
    v_mfma_f32_32x32x16_bf16 v[100:115], v[68:71], v[72:75], v[100:115]
    s_sleep 1
    ds_read_b128 v[60:63], v150 offset:16384
    ds_read_b128 v[64:67], v154 offset:16384
    s_waitcnt lgkmcnt(6)
    v_mfma_f32_32x32x16_bf16 v[100:115], v[76:79], v[80:83], v[100:115]
    s_sleep 1
    ds_read_b128 v[68:71], v151 offset:16384
    ds_read_b128 v[72:75], v155 offset:16384
    s_waitcnt lgkmcnt(6)
    v_mfma_f32_32x32x16_bf16 v[100:115], v[84:87], v[88:91], v[100:115]
    s_sleep 1
    s_waitcnt lgkmcnt(4)
    v_mfma_f32_32x32x16_bf16 v[100:115], v[52:55], v[56:59], v[100:115]
    s_sleep 1
    s_waitcnt lgkmcnt(2)
    v_mfma_f32_32x32x16_bf16 v[100:115], v[60:63], v[64:67], v[100:115]
    s_sleep 1
    s_waitcnt lgkmcnt(0)
    v_mfma_f32_32x32x16_bf16 v[100:115], v[68:71], v[72:75], v[100:115]
    s_sleep 1
    s_mov_b64 exec, 1
    ds_add_u32 v163, v167
    s_mov_b64 exec, -1
    s_mov_b32 s55, 0x40000
L_poll_86:
    ds_read_b32 v161, v163
    s_waitcnt lgkmcnt(0)
    v_readfirstlane_b32 s46, v161
    s_cmp_ge_u32 s46, 8
    s_cbranch_scc1 L_done_87
    s_sleep 1
    s_sub_u32 s55, s55, 1
    s_cbranch_scc0 L_poll_86
L_done_87:
    s_cmp_eq_u32 s45, 0
    s_cbranch_scc1 L_norecv_88
    s_add_u32 s48, s45, 2
    s_add_u32 s49, s45, 5
    s_cmp_eq_u32 s45, 3
    s_cselect_b32 s49, 5, s49
    s_lshl_b32 s46, s48, 8
    s_add_u32 s46, s46, s36
    s_lshl_b32 s46, s46, 11
    s_add_u32 s56, s46, 524288
    s_lshl_b32 s46, s49, 8
    s_add_u32 s46, s46, s36
    s_lshl_b32 s46, s46, 11
    s_add_u32 s57, s46, 524288
    s_mov_b32 s55, 0x20000
    buffer_load_dwordx4 v[116:119], v156, s[4:7], s56 offen offset:0 sc1
    buffer_load_dwordx4 v[120:123], v156, s[4:7], s56 offen offset:1024 sc1
    buffer_load_dwordx4 v[124:127], v156, s[4:7], s57 offen offset:0 sc1
    buffer_load_dwordx4 v[128:131], v156, s[4:7], s57 offen offset:1024 sc1
    s_add_u32 s46, s42, 4
    s_and_b32 s46, s46, 7
    s_lshl_b32 s46, s46, 7
    s_add_u32 s47, s46, s50
    s_add_u32 m0, s52, 65536
    s_add_u32 s46, s46, s51
    buffer_load_dwordx4 v132, s[32:35], s47 offen lds
    s_add_u32 m0, s52, 66560
    s_nop 0
    buffer_load_dwordx4 v133, s[32:35], s47 offen lds
    s_add_u32 m0, s52, 73728
    s_nop 0
    buffer_load_dwordx4 v134, s[12:15], s46 offen lds
    s_add_u32 m0, s52, 74752
    s_add_u32 s46, s46, 16384
    s_mov_b32 exec_hi, s53
    buffer_load_dwordx4 v135, s[12:15], s46 offen lds
    s_mov_b32 exec_hi, -1
    s_add_u32 s46, s42, 5
    s_and_b32 s46, s46, 7
    s_lshl_b32 s46, s46, 7
    s_add_u32 s47, s46, s50
    s_add_u32 m0, s52, 81920
    s_add_u32 s46, s46, s51
    buffer_load_dwordx4 v132, s[32:35], s47 offen lds
    s_add_u32 m0, s52, 82944
    s_nop 0
    buffer_load_dwordx4 v133, s[32:35], s47 offen lds
    s_add_u32 m0, s52, 90112
    s_nop 0
    buffer_load_dwordx4 v134, s[12:15], s46 offen lds
    s_add_u32 m0, s52, 91136
    s_add_u32 s46, s46, 16384
    s_mov_b32 exec_hi, s53
    buffer_load_dwordx4 v135, s[12:15], s46 offen lds
    s_mov_b32 exec_hi, -1
    s_waitcnt vmcnt(8)
    s_branch L_qchk_91
L_qtry_89:
    buffer_load_dwordx4 v[116:119], v156, s[4:7], s56 offen offset:0 sc1
    buffer_load_dwordx4 v[120:123], v156, s[4:7], s56 offen offset:1024 sc1
    buffer_load_dwordx4 v[124:127], v156, s[4:7], s57 offen offset:0 sc1
    buffer_load_dwordx4 v[128:131], v156, s[4:7], s57 offen offset:1024 sc1
    s_waitcnt vmcnt(0)
L_qchk_91:
    v_xor_b32 v1, s43, v117
    v_bitop3_b32 v1, v1, v119, s43 bitop3:0xf6
    v_bitop3_b32 v1, v1, v121, s43 bitop3:0xf6
    v_bitop3_b32 v1, v1, v123, s43 bitop3:0xf6
    v_bitop3_b32 v1, v1, v125, s43 bitop3:0xf6
    v_bitop3_b32 v1, v1, v127, s43 bitop3:0xf6
    v_bitop3_b32 v1, v1, v129, s43 bitop3:0xf6
    v_bitop3_b32 v1, v1, v131, s43 bitop3:0xf6
    v_cmp_ne_u32 vcc, 0, v1
    s_cmp_eq_u64 vcc, 0
    s_cbranch_scc1 L_qok_90
    s_sleep 6
    s_sub_u32 s55, s55, 1
    s_cbranch_scc0 L_qtry_89
L_qok_90:
    v_mov_b32 v117, v118
    v_mov_b32 v118, v120
    v_mov_b32 v119, v122
    v_mov_b32 v125, v126
    v_mov_b32 v126, v128
    v_mov_b32 v127, v130
    s_nop 0
    v_mfma_f32_32x32x16_bf16 v[52:67], v[44:47], v[116:119], 0
    v_mfma_f32_32x32x16_bf16 v[68:83], v[44:47], v[124:127], 0
    s_lshl_b32 s46, s48, 10
    s_add_u32 s46, s46, 147456
    v_add_u32 v1, s46, v156
    ds_write_b128 v1, v[116:119]
    s_lshl_b32 s46, s48, 9
    s_add_u32 s46, s46, 155648
    v_and_b32 v1, 31, v0
    v_lshl_add_u32 v84, v1, 4, s46
    s_lshl_b32 s46, s49, 10
    s_add_u32 s46, s46, 147456
    v_add_u32 v1, s46, v156
    ds_write_b128 v1, v[124:127]
    s_lshl_b32 s46, s49, 9
    s_add_u32 s46, s46, 155648
    v_and_b32 v1, 31, v0
    v_lshl_add_u32 v85, v1, 4, s46
    v_max3_f32 v161, v52, v53, v54
    v_max3_f32 v161, v161, v55, v56
    v_max3_f32 v161, v161, v57, v58
    v_max3_f32 v161, v161, v59, v60
    v_max3_f32 v161, v161, v61, v62
    v_max3_f32 v161, v161, v63, v64
    v_max3_f32 v161, v161, v65, v66
    v_max_f32 v161, v161, v67
    v_max3_f32 v162, v68, v69, v70
    v_max3_f32 v162, v162, v71, v72
    v_max3_f32 v162, v162, v73, v74
    v_max3_f32 v162, v162, v75, v76
    v_max3_f32 v162, v162, v77, v78
    v_max3_f32 v162, v162, v79, v80
    v_max3_f32 v162, v162, v81, v82
    v_max_f32 v162, v162, v83
    s_nop 1
    v_permlane32_swap_b32 v161, v162
    s_nop 1
    v_max_f32 v161, v161, v162
    v_sub_f32 v52, 0xc2d00000, v161
    s_mov_b32 exec_lo, 0
    v_mov_b32 v84, v85
    s_mov_b32 exec_lo, -1
    v_mov_b32 v53, v52
    v_mov_b32 v54, v52
    v_mov_b32 v55, v52
    ds_write_b128 v84, v[52:55]
    s_branch L_norecv_88b
L_norecv_88:
    s_add_u32 s46, s42, 4
    s_and_b32 s46, s46, 7
    s_lshl_b32 s46, s46, 7
    s_add_u32 s47, s46, s50
    s_add_u32 m0, s52, 65536
    s_add_u32 s46, s46, s51
    buffer_load_dwordx4 v132, s[32:35], s47 offen lds
    s_add_u32 m0, s52, 66560
    s_nop 0
    buffer_load_dwordx4 v133, s[32:35], s47 offen lds
    s_add_u32 m0, s52, 73728
    s_nop 0
    buffer_load_dwordx4 v134, s[12:15], s46 offen lds
    s_add_u32 m0, s52, 74752
    s_add_u32 s46, s46, 16384
    s_mov_b32 exec_hi, s53
    buffer_load_dwordx4 v135, s[12:15], s46 offen lds
    s_mov_b32 exec_hi, -1
    s_add_u32 s46, s42, 5
    s_and_b32 s46, s46, 7
    s_lshl_b32 s46, s46, 7
    s_add_u32 s47, s46, s50
    s_add_u32 m0, s52, 81920
    s_add_u32 s46, s46, s51
    buffer_load_dwordx4 v132, s[32:35], s47 offen lds
    s_add_u32 m0, s52, 82944
    s_nop 0
    buffer_load_dwordx4 v133, s[32:35], s47 offen lds
    s_add_u32 m0, s52, 90112
    s_nop 0
    buffer_load_dwordx4 v134, s[12:15], s46 offen lds
    s_add_u32 m0, s52, 91136
    s_add_u32 s46, s46, 16384
    s_mov_b32 exec_hi, s53
    buffer_load_dwordx4 v135, s[12:15], s46 offen lds
    s_mov_b32 exec_hi, -1
L_norecv_88b:
    s_mov_b64 exec, 1
    ds_add_u32 v166, v167
    s_mov_b64 exec, -1
    s_branch H_f4_skip
H_f4:
    s_setpc_b64 s[100:101]
H_f4_skip:
    ds_read_b128 v[76:79], v148 offset:32768
    ds_read_b128 v[80:83], v152 offset:32768
    ds_read_b128 v[84:87], v149 offset:32768
    ds_read_b128 v[88:91], v153 offset:32768
    ds_read_b128 v[52:55], v150 offset:32768
    ds_read_b128 v[56:59], v154 offset:32768
    ds_read_b128 v[60:63], v151 offset:32768
    ds_read_b128 v[64:67], v155 offset:32768
    s_waitcnt lgkmcnt(6)
    v_mfma_f32_32x32x16_bf16 v[100:115], v[76:79], v[80:83], v[100:115]
    s_sleep 1
    ds_read_b128 v[68:71], v148 offset:49152
    ds_read_b128 v[72:75], v152 offset:49152
    s_waitcnt lgkmcnt(6)
    v_mfma_f32_32x32x16_bf16 v[100:115], v[84:87], v[88:91], v[100:115]
    s_sleep 1
    ds_read_b128 v[76:79], v149 offset:49152
    ds_read_b128 v[80:83], v153 offset:49152
    s_waitcnt lgkmcnt(6)
    v_mfma_f32_32x32x16_bf16 v[100:115], v[52:55], v[56:59], v[100:115]
    s_sleep 1
    ds_read_b128 v[84:87], v150 offset:49152
    ds_read_b128 v[88:91], v154 offset:49152
    s_waitcnt lgkmcnt(6)
    v_mfma_f32_32x32x16_bf16 v[100:115], v[60:63], v[64:67], v[100:115]
    s_sleep 1
    ds_read_b128 v[52:55], v151 offset:49152
    ds_read_b128 v[56:59], v155 offset:49152
    s_waitcnt lgkmcnt(6)
    v_mfma_f32_32x32x16_bf16 v[100:115], v[68:71], v[72:75], v[100:115]
    s_sleep 1
    s_waitcnt lgkmcnt(4)
    v_mfma_f32_32x32x16_bf16 v[100:115], v[76:79], v[80:83], v[100:115]
    s_sleep 1
    s_waitcnt lgkmcnt(2)
    v_mfma_f32_32x32x16_bf16 v[100:115], v[84:87], v[88:91], v[100:115]
    s_sleep 1
    s_waitcnt lgkmcnt(0)
    v_mfma_f32_32x32x16_bf16 v[100:115], v[52:55], v[56:59], v[100:115]
    s_sleep 1
    s_mov_b64 exec, 1
    ds_add_u32 v163, v167
    s_mov_b64 exec, -1
    s_mov_b32 s55, 0x40000
L_poll_92:
    ds_read_b32 v161, v163
    s_waitcnt lgkmcnt(0)
    v_readfirstlane_b32 s46, v161
    s_cmp_ge_u32 s46, 12
    s_cbranch_scc1 L_done_93
    s_sleep 1
    s_sub_u32 s55, s55, 1
    s_cbranch_scc0 L_poll_92
L_done_93:
    s_add_u32 s46, s42, 6
    s_and_b32 s46, s46, 7
    s_lshl_b32 s46, s46, 7
    s_add_u32 s47, s46, s50
    s_add_u32 m0, s52, 98304
    s_add_u32 s46, s46, s51
    buffer_load_dwordx4 v132, s[32:35], s47 offen lds
    s_add_u32 m0, s52, 99328
    s_nop 0
    buffer_load_dwordx4 v133, s[32:35], s47 offen lds
    s_add_u32 m0, s52, 106496
    s_nop 0
    buffer_load_dwordx4 v134, s[12:15], s46 offen lds
    s_add_u32 m0, s52, 107520
    s_add_u32 s46, s46, 16384
    s_mov_b32 exec_hi, s53
    buffer_load_dwordx4 v135, s[12:15], s46 offen lds
    s_mov_b32 exec_hi, -1
    s_add_u32 s46, s42, 7
    s_and_b32 s46, s46, 7
    s_lshl_b32 s46, s46, 7
    s_add_u32 s47, s46, s50
    s_add_u32 m0, s52, 114688
    s_add_u32 s46, s46, s51
    buffer_load_dwordx4 v132, s[32:35], s47 offen lds
    s_add_u32 m0, s52, 115712
    s_nop 0
    buffer_load_dwordx4 v133, s[32:35], s47 offen lds
    s_add_u32 m0, s52, 122880
    s_nop 0
    buffer_load_dwordx4 v134, s[12:15], s46 offen lds
    s_add_u32 m0, s52, 123904
    s_add_u32 s46, s46, 16384
    s_mov_b32 exec_hi, s53
    buffer_load_dwordx4 v135, s[12:15], s46 offen lds
    s_mov_b32 exec_hi, -1
    s_getpc_b64 s[96:97]
L_pc_94:
    s_add_u32 s96, s96, dft_tab+0-L_pc_94
    s_addc_u32 s97, s97, 0
    global_load_dwordx4 v[132:135], v156, s[96:97] offset:0
    global_load_dwordx4 v[136:139], v156, s[96:97] offset:1024
    global_load_dwordx4 v[140:143], v156, s[96:97] offset:2048
    global_load_dwordx4 v[144:147], v156, s[96:97] offset:3072
    buffer_load_dword v49, v48, s[4:7], 0 offen sc1
    s_waitcnt vmcnt(13)
    s_mov_b64 exec, 1
    ds_add_u32 v163, v167
    s_mov_b64 exec, -1
    s_mov_b32 s55, 0x40000
L_poll_95:
    ds_read_b32 v161, v163
    s_waitcnt lgkmcnt(0)
    v_readfirstlane_b32 s46, v161
    s_cmp_ge_u32 s46, 16
    s_cbranch_scc1 L_done_96
    s_sleep 1
    s_sub_u32 s55, s55, 1
    s_cbranch_scc0 L_poll_95
L_done_96:
    ds_read_b128 v[60:63], v148 offset:0
    ds_read_b128 v[64:67], v152 offset:0
    ds_read_b128 v[68:71], v149 offset:0
    ds_read_b128 v[72:75], v153 offset:0
    ds_read_b128 v[76:79], v150 offset:0
    ds_read_b128 v[80:83], v154 offset:0
    ds_read_b128 v[84:87], v151 offset:0
    ds_read_b128 v[88:91], v155 offset:0
    s_waitcnt lgkmcnt(6)
    v_mfma_f32_32x32x16_bf16 v[100:115], v[60:63], v[64:67], v[100:115]
    s_sleep 1
    ds_read_b128 v[52:55], v148 offset:16384
    ds_read_b128 v[56:59], v152 offset:16384
    s_waitcnt lgkmcnt(6)
    v_mfma_f32_32x32x16_bf16 v[100:115], v[68:71], v[72:75], v[100:115]
    s_sleep 1
    ds_read_b128 v[60:63], v149 offset:16384
    ds_read_b128 v[64:67], v153 offset:16384
    s_waitcnt lgkmcnt(6)
    v_mfma_f32_32x32x16_bf16 v[100:115], v[76:79], v[80:83], v[100:115]
    s_sleep 1
    ds_read_b128 v[68:71], v150 offset:16384
    ds_read_b128 v[72:75], v154 offset:16384
    s_waitcnt lgkmcnt(6)
    v_mfma_f32_32x32x16_bf16 v[100:115], v[84:87], v[88:91], v[100:115]
    s_sleep 1
    ds_read_b128 v[76:79], v151 offset:16384
    ds_read_b128 v[80:83], v155 offset:16384
    s_waitcnt lgkmcnt(6)
    v_mfma_f32_32x32x16_bf16 v[100:115], v[52:55], v[56:59], v[100:115]
    s_sleep 1
    s_waitcnt lgkmcnt(4)
    v_mfma_f32_32x32x16_bf16 v[100:115], v[60:63], v[64:67], v[100:115]
    s_sleep 1
    s_waitcnt lgkmcnt(2)
    v_mfma_f32_32x32x16_bf16 v[100:115], v[68:71], v[72:75], v[100:115]
    s_sleep 1
    s_waitcnt lgkmcnt(0)
    v_mfma_f32_32x32x16_bf16 v[100:115], v[76:79], v[80:83], v[100:115]
    s_sleep 1
    s_waitcnt vmcnt(5)
    s_mov_b64 exec, 1
    ds_add_u32 v163, v167
    s_mov_b64 exec, -1
    s_mov_b32 s55, 0x40000
L_poll_97:
    ds_read_b32 v161, v163
    s_waitcnt lgkmcnt(0)
    v_readfirstlane_b32 s46, v161
    s_cmp_ge_u32 s46, 20
    s_cbranch_scc1 L_done_98
    s_sleep 1
    s_sub_u32 s55, s55, 1
    s_cbranch_scc0 L_poll_97
L_done_98:
    ds_read_b128 v[84:87], v148 offset:32768
    ds_read_b128 v[88:91], v152 offset:32768
    ds_read_b128 v[52:55], v149 offset:32768
    ds_read_b128 v[56:59], v153 offset:32768
    ds_read_b128 v[60:63], v150 offset:32768
    ds_read_b128 v[64:67], v154 offset:32768
    ds_read_b128 v[68:71], v151 offset:32768
    ds_read_b128 v[72:75], v155 offset:32768
    s_waitcnt lgkmcnt(6)
    v_mfma_f32_32x32x16_bf16 v[100:115], v[84:87], v[88:91], v[100:115]
    s_sleep 1
    ds_read_b128 v[76:79], v148 offset:49152
    ds_read_b128 v[80:83], v152 offset:49152
    s_waitcnt lgkmcnt(6)
    v_mfma_f32_32x32x16_bf16 v[100:115], v[52:55], v[56:59], v[100:115]
    s_sleep 1
    ds_read_b128 v[84:87], v149 offset:49152
    ds_read_b128 v[88:91], v153 offset:49152
    s_waitcnt lgkmcnt(6)
    v_mfma_f32_32x32x16_bf16 v[100:115], v[60:63], v[64:67], v[100:115]
    s_sleep 1
    ds_read_b128 v[52:55], v150 offset:49152
    ds_read_b128 v[56:59], v154 offset:49152
    s_waitcnt lgkmcnt(6)
    v_mfma_f32_32x32x16_bf16 v[100:115], v[68:71], v[72:75], v[100:115]
    s_sleep 1
    ds_read_b128 v[60:63], v151 offset:49152
    ds_read_b128 v[64:67], v155 offset:49152
    s_waitcnt lgkmcnt(6)
    v_mfma_f32_32x32x16_bf16 v[100:115], v[76:79], v[80:83], v[100:115]
    s_sleep 1
    s_waitcnt lgkmcnt(4)
    v_mfma_f32_32x32x16_bf16 v[100:115], v[84:87], v[88:91], v[100:115]
    s_sleep 1
    s_waitcnt lgkmcnt(2)
    v_mfma_f32_32x32x16_bf16 v[100:115], v[52:55], v[56:59], v[100:115]
    s_sleep 1
    s_waitcnt lgkmcnt(0)
    v_mfma_f32_32x32x16_bf16 v[100:115], v[60:63], v[64:67], v[100:115]
    s_sleep 1
    s_branch H_f5_skip
H_f5:
    s_setpc_b64 s[100:101]
H_f5_skip:
    s_lshl_b32 s50, s40, 1
    s_add_u32 s50, s50, s91
    s_lshl_b32 s51, s45, 19
    s_lshl_b32 s47, s41, 13
    s_add_u32 s51, s51, s47
    s_lshl_b32 s47, s40, 7
    s_add_u32 s51, s51, s47
    s_add_u32 s51, s51, 4718592
    s_add_u32 s52, s51, 0x40000
    s_nop 2
    v_cvt_pk_bf16_f32 v148, v100, v101
    v_cvt_pk_bf16_f32 v149, v102, v103
    v_cvt_pk_bf16_f32 v150, v104, v105
    v_cvt_pk_bf16_f32 v151, v106, v107
    v_cvt_pk_bf16_f32 v152, v108, v109
    v_cvt_pk_bf16_f32 v153, v110, v111
    v_cvt_pk_bf16_f32 v154, v112, v113
    v_cvt_pk_bf16_f32 v155, v114, v115
    s_waitcnt vmcnt(0)
    s_mov_b32 s55, 0x20000
L_gp_99:
    v_cmp_ne_u32 vcc, s43, v49
    s_cmp_eq_u64 vcc, 0
    s_cbranch_scc1 L_gpd_100
    s_sleep 2
    buffer_load_dword v49, v48, s[4:7], 0 offen sc1
    s_waitcnt vmcnt(0)
    s_sub_u32 s55, s55, 1
    s_cbranch_scc0 L_gp_99
L_gpd_100:
    s_add_u32 s47, s41, s63
    s_and_b32 s47, s47, 7
    s_lshl_b32 s47, s47, 2
    s_add_u32 s47, s47, s45
    s_lshl_b32 s47, s47, 14
    s_add_u32 s47, s47, 524288
    buffer_load_dwordx4 v[36:39], v156, s[4:7], s47 offen offset:0 sc1
    buffer_load_dwordx4 v[40:43], v156, s[4:7], s47 offen offset:1024 sc1
    buffer_load_dwordx4 v[44:47], v156, s[4:7], s47 offen offset:2048 sc1
    buffer_load_dwordx4 v[48:51], v156, s[4:7], s47 offen offset:3072 sc1
    s_add_u32 s47, s47, 4096
    buffer_load_dwordx4 v[52:55], v156, s[4:7], s47 offen offset:0 sc1
    buffer_load_dwordx4 v[56:59], v156, s[4:7], s47 offen offset:1024 sc1
    buffer_load_dwordx4 v[60:63], v156, s[4:7], s47 offen offset:2048 sc1
    buffer_load_dwordx4 v[64:67], v156, s[4:7], s47 offen offset:3072 sc1
    s_mov_b32 s58, s47
    v_mfma_f32_32x32x16_bf16 v[100:115], v[148:151], v[132:135], 0
    v_mfma_f32_32x32x16_bf16 v[116:131], v[148:151], v[140:143], 0
    v_mfma_f32_32x32x16_bf16 v[100:115], v[152:155], v[136:139], v[100:115]
    v_mfma_f32_32x32x16_bf16 v[116:131], v[152:155], v[144:147], v[116:131]
    v_and_b32 v1, 31, v0
    v_mul_u32_u24 v1, s50, v1
    v_cvt_f32_u32 v1, v1
    v_mul_f32 v1, 0x3a000000, v1
    v_cos_f32 v162, v1
    v_sin_f32 v3, v1
    s_nop 5
    s_lshl_b32 s46, s41, 1
    s_add_u32 s46, s46, s60
    s_cmp_lg_u32 s46, 15
    s_cbranch_scc1 L_nospec_101
    v_and_b32 v1, 31, v0
    v_lshlrev_b32 v1, 2, v1
    s_mov_b32 exec_lo, 0
    v_mul_f32 v148, v162, v115
    v_mul_f32 v149, v3, v115
    v_fma_f32 v148, v3, v131, v148
    v_fma_f32 v149, -v162, v131, v149
    v_cvt_pk_bf16_f32 v161, v148, v149
    s_lshl_b32 s50, s50, 7
    s_add_u32 s50, s50, 327680
    buffer_store_dword v161, v1, s[4:7], s50 offen sc1
    v_mov_b32 v115, 0
    v_mov_b32 v131, 0
    s_mov_b32 exec_lo, -1
L_nospec_101:
    v_mov_b32 v148, v162
    v_mov_b32 v149, v3
    v_pk_add_f32 v[100:101], v[100:101], v[124:125] neg_lo:[0,1] neg_hi:[0,1]
    v_pk_add_f32 v[116:117], v[116:117], v[108:109] neg_lo:[1,1] neg_hi:[1,1]
    v_pk_mul_f32 v[108:109], v[116:117], v[148:149] op_sel:[0,1] op_sel_hi:[1,1]
    v_pk_mul_f32 v[124:125], v[100:101], v[148:149] op_sel:[0,1] op_sel_hi:[1,1]
    v_pk_fma_f32 v[100:101], v[100:101], v[148:149], v[108:109] op_sel_hi:[1,0,1] neg_lo:[0,0,1] neg_hi:[0,0,1]
    v_pk_fma_f32 v[116:117], v[116:117], v[148:149], v[124:125] op_sel_hi:[1,0,1]
    v_pk_add_f32 v[102:103], v[102:103], v[126:127] neg_lo:[0,1] neg_hi:[0,1]
    v_pk_add_f32 v[118:119], v[118:119], v[110:111] neg_lo:[1,1] neg_hi:[1,1]
    v_pk_mul_f32 v[110:111], v[118:119], v[148:149] op_sel:[0,1] op_sel_hi:[1,1]
    v_pk_mul_f32 v[126:127], v[102:103], v[148:149] op_sel:[0,1] op_sel_hi:[1,1]
    v_pk_fma_f32 v[102:103], v[102:103], v[148:149], v[110:111] op_sel_hi:[1,0,1] neg_lo:[0,0,1] neg_hi:[0,0,1]
    v_pk_fma_f32 v[118:119], v[118:119], v[148:149], v[126:127] op_sel_hi:[1,0,1]
    v_pk_add_f32 v[104:105], v[104:105], v[128:129] neg_lo:[0,1] neg_hi:[0,1]
    v_pk_add_f32 v[120:121], v[120:121], v[112:113] neg_lo:[1,1] neg_hi:[1,1]
    v_pk_mul_f32 v[112:113], v[120:121], v[148:149] op_sel:[0,1] op_sel_hi:[1,1]
    v_pk_mul_f32 v[128:129], v[104:105], v[148:149] op_sel:[0,1] op_sel_hi:[1,1]
    v_pk_fma_f32 v[104:105], v[104:105], v[148:149], v[112:113] op_sel_hi:[1,0,1] neg_lo:[0,0,1] neg_hi:[0,0,1]
    v_pk_fma_f32 v[120:121], v[120:121], v[148:149], v[128:129] op_sel_hi:[1,0,1]
    v_pk_add_f32 v[106:107], v[106:107], v[130:131] neg_lo:[0,1] neg_hi:[0,1]
    v_pk_add_f32 v[122:123], v[122:123], v[114:115] neg_lo:[1,1] neg_hi:[1,1]
    v_pk_mul_f32 v[114:115], v[122:123], v[148:149] op_sel:[0,1] op_sel_hi:[1,1]
    v_pk_mul_f32 v[130:131], v[106:107], v[148:149] op_sel:[0,1] op_sel_hi:[1,1]
    v_pk_fma_f32 v[106:107], v[106:107], v[148:149], v[114:115] op_sel_hi:[1,0,1] neg_lo:[0,0,1] neg_hi:[0,0,1]
    v_pk_fma_f32 v[122:123], v[122:123], v[148:149], v[130:131] op_sel_hi:[1,0,1]
    v_cvt_pk_bf16_f32 v148, v100, v101
    v_cvt_pk_bf16_f32 v152, v116, v117
    v_cvt_pk_bf16_f32 v149, v102, v103
    v_cvt_pk_bf16_f32 v153, v118, v119
    v_cvt_pk_bf16_f32 v150, v104, v105
    v_cvt_pk_bf16_f32 v154, v120, v121
    v_cvt_pk_bf16_f32 v151, v106, v107
    v_cvt_pk_bf16_f32 v155, v122, v123
    v_and_b32 v1, 31, v0
    v_lshrrev_b32 v3, 5, v0
    v_lshlrev_b32 v1, 8, v1
    v_lshl_add_u32 v1, v3, 4, v1
    s_lshl_b32 s46, s91, 6
    s_lshl_b32 s47, s60, 5
    s_add_u32 s46, s46, s47
    s_add_u32 s46, s46, 139264
    v_add_u32 v1, s46, v1
    ds_write_b128 v1, v[148:151]
    ds_write_b128 v1, v[152:155] offset:128
    s_mov_b64 exec, 1
    ds_add_u32 v163, v167
    s_mov_b64 exec, -1
    s_mov_b32 s55, 0x40000
L_poll_102:
    ds_read_b32 v161, v163
    s_waitcnt lgkmcnt(0)
    v_readfirstlane_b32 s46, v161
    s_cmp_ge_u32 s46, 24
    s_cbranch_scc1 L_done_103
    s_sleep 1
    s_sub_u32 s55, s55, 1
    s_cbranch_scc0 L_poll_102
L_done_103:
    s_lshl_b32 s46, s45, 11
    s_add_u32 s46, s46, 139264
    v_add_u32 v1, s46, v156
    ds_read_b128 v[100:103], v1
    ds_read_b128 v[104:107], v1 offset:1024
    v_lshrrev_b32 v1, 4, v0
    v_bfe_u32 v3, v0, 3, 1
    v_lshlrev_b32 v1, 16, v1
    v_lshl_add_u32 v1, v3, 12, v1
    v_and_b32 v3, 7, v0
    v_lshl_add_u32 v1, v3, 4, v1
    s_waitcnt lgkmcnt(1)
    buffer_store_dwordx4 v[100:103], v1, s[4:7], s51 offen sc1
    s_waitcnt lgkmcnt(0)
    buffer_store_dwordx4 v[104:107], v1, s[4:7], s52 offen sc1
    s_lshl_b32 s46, s2, 2
    s_add_u32 s46, s46, s45
    s_cmp_eq_u32 s46, 3
    s_cselect_b32 s56, 4, 9
    s_cmp_lt_u32 s45, 2
    s_cselect_b32 s56, 3, s56
    s_mov_b32 s59, 1
    s_mov_b32 s57, 1
    s_mov_b32 s49, 0
    s_branch H_op_skip
H_op:
    s_setpc_b64 s[100:101]
H_op_skip:
L_op:
    s_and_b32 s47, s44, 3
    s_lshl_b32 s48, s47, 10
    s_add_u32 s48, s48, 131072
    s_lshl_b32 s47, s47, 14
    v_add_u32 v1, s47, v158
    v_add_u32 v3, s48, v159
    s_cmp_eq_u32 s44, 7
    s_cbranch_scc1 L_last_104
    ds_read_b32 v161, v160
    ds_read2_b32 v[116:117], v3 offset0:0 offset1:32
    ds_read2_b32 v[118:119], v3 offset0:64 offset1:96
    ds_read2_b32 v[120:121], v3 offset0:128 offset1:160
    ds_read2_b32 v[122:123], v3 offset0:192 offset1:224
    ds_read_b64 v[100:101], v1 offset:0
    ds_read_b64 v[102:103], v1 offset:2048
    ds_read_b64 v[104:105], v1 offset:4096
    ds_read_b64 v[106:107], v1 offset:6144
    ds_read_b64 v[108:109], v1 offset:8192
    ds_read_b64 v[110:111], v1 offset:10240
    ds_read_b64 v[112:113], v1 offset:12288
    ds_read_b64 v[114:115], v1 offset:14336
    s_lshl_b32 s54, s44, 10
    s_add_u32 s54, s54, 148480
    s_waitcnt lgkmcnt(12)
    v_cmp_le_u32 vcc, s54, v161
    s_cmp_eq_u64 vcc, -1
    s_cbranch_scc1 L_go_105
    s_cmp_eq_u32 s57, 0
    s_cbranch_scc1 L_nopend_107
    s_mov_b32 s57, 0
    s_mov_b32 s47, s58
    s_add_u32 s47, s47, 4096
    buffer_load_dwordx4 v[68:71], v156, s[4:7], s47 offen offset:0 sc1
    buffer_load_dwordx4 v[72:75], v156, s[4:7], s47 offen offset:1024 sc1
    buffer_load_dwordx4 v[76:79], v156, s[4:7], s47 offen offset:2048 sc1
    buffer_load_dwordx4 v[80:83], v156, s[4:7], s47 offen offset:3072 sc1
    s_add_u32 s47, s47, 4096
    buffer_load_dwordx4 v[84:87], v156, s[4:7], s47 offen offset:0 sc1
    buffer_load_dwordx4 v[88:91], v156, s[4:7], s47 offen offset:1024 sc1
    buffer_load_dwordx4 v[92:95], v156, s[4:7], s47 offen offset:2048 sc1
    buffer_load_dwordx4 v[96:99], v156, s[4:7], s47 offen offset:3072 sc1
L_nopend_107:
    s_mov_b32 s55, 0x40000
L_fpoll_106:
    s_sleep 5
    ds_read_b32 v161, v160
    s_waitcnt lgkmcnt(0)
    v_cmp_le_u32 vcc, s54, v161
    s_cmp_eq_u64 vcc, -1
    s_cbranch_scc1 L_go_105r
    s_sub_u32 s55, s55, 1
    s_cbranch_scc0 L_fpoll_106
    s_branch L_go_105r
L_last_104:
    s_cmp_eq_u32 s57, 0
    s_cbranch_scc1 L_nopend_108
    s_mov_b32 s57, 0
    s_mov_b32 s47, s58
    s_add_u32 s47, s47, 4096
    buffer_load_dwordx4 v[68:71], v156, s[4:7], s47 offen offset:0 sc1
    buffer_load_dwordx4 v[72:75], v156, s[4:7], s47 offen offset:1024 sc1
    buffer_load_dwordx4 v[76:79], v156, s[4:7], s47 offen offset:2048 sc1
    buffer_load_dwordx4 v[80:83], v156, s[4:7], s47 offen offset:3072 sc1
    s_add_u32 s47, s47, 4096
    buffer_load_dwordx4 v[84:87], v156, s[4:7], s47 offen offset:0 sc1
    buffer_load_dwordx4 v[88:91], v156, s[4:7], s47 offen offset:1024 sc1
    buffer_load_dwordx4 v[92:95], v156, s[4:7], s47 offen offset:2048 sc1
    buffer_load_dwordx4 v[96:99], v156, s[4:7], s47 offen offset:3072 sc1
L_nopend_108:
    v_bfe_u32 v163, v0, 4, 1
    v_lshrrev_b32 v162, 5, v0
    v_lshlrev_b32 v163, 13, v163
    v_lshl_add_u32 v163, v162, 12, v163
    v_and_b32 v162, 15, v0
    v_lshl_add_u32 v163, v162, 4, v163
    s_lshl_b32 s58, s36, 14
    s_lshl_b32 s46, s45, 8
    s_add_u32 s58, s58, s46
    s_barrier
L_go_105r:
    ds_read2_b32 v[116:117], v3 offset0:0 offset1:32
    ds_read2_b32 v[118:119], v3 offset0:64 offset1:96
    ds_read2_b32 v[120:121], v3 offset0:128 offset1:160
    ds_read2_b32 v[122:123], v3 offset0:192 offset1:224
    ds_read_b64 v[100:101], v1 offset:0
    ds_read_b64 v[102:103], v1 offset:2048
    ds_read_b64 v[104:105], v1 offset:4096
    ds_read_b64 v[106:107], v1 offset:6144
    ds_read_b64 v[108:109], v1 offset:8192
    ds_read_b64 v[110:111], v1 offset:10240
    ds_read_b64 v[112:113], v1 offset:12288
    ds_read_b64 v[114:115], v1 offset:14336
L_go_105:
    s_waitcnt lgkmcnt(8)
    v_pk_add_f32 v[116:117], v[116:117], v[118:119]
    v_pk_add_f32 v[120:121], v[120:121], v[122:123]
    v_pk_add_f32 v[116:117], v[116:117], v[120:121]
    s_waitcnt lgkmcnt(4)
    v_pk_add_f32 v[100:101], v[100:101], v[102:103]
    v_add_f32 v116, v116, v117
    v_pk_add_f32 v[104:105], v[104:105], v[106:107]
    s_waitcnt lgkmcnt(0)
    v_pk_add_f32 v[108:109], v[108:109], v[110:111]
    v_rcp_f32 v117, v116
    v_pk_add_f32 v[112:113], v[112:113], v[114:115]
    v_mul_f32 v116, 0x43800000, v116
    v_pk_add_f32 v[100:101], v[100:101], v[104:105]
    v_pk_add_f32 v[108:109], v[108:109], v[112:113]
    v_fma_f32 v117, v116, 0, v117
    v_pk_add_f32 v[100:101], v[100:101], v[108:109]
    s_and_b32 s47, s44, 1
    s_lshl_b32 s47, s47, 10
    s_add_u32 s48, s47, 159744
    v_mul_f32 v100, v100, v117
    v_mul_f32 v101, v101, v117
    v_add_u32 v1, s47, v164
    v_cvt_pk_bf16_f32 v100, v100, v101
    v_add_u32 v3, s48, v156
    ds_write_b32 v1, v100
    s_cmp_eq_u32 s44, 7
    s_cbranch_scc1 L_s7_109
    s_mov_b64 exec, 1
    ds_add_u32 v166, v167
    s_mov_b64 exec, -1
    s_cmp_eq_u32 s57, 0
    s_cbranch_scc1 L_nopend_112
    s_mov_b32 s57, 0
    s_mov_b32 s47, s58
    s_add_u32 s47, s47, 4096
    buffer_load_dwordx4 v[68:71], v156, s[4:7], s47 offen offset:0 sc1
    buffer_load_dwordx4 v[72:75], v156, s[4:7], s47 offen offset:1024 sc1
    buffer_load_dwordx4 v[76:79], v156, s[4:7], s47 offen offset:2048 sc1
    buffer_load_dwordx4 v[80:83], v156, s[4:7], s47 offen offset:3072 sc1
    s_add_u32 s47, s47, 4096
    buffer_load_dwordx4 v[84:87], v156, s[4:7], s47 offen offset:0 sc1
    buffer_load_dwordx4 v[88:91], v156, s[4:7], s47 offen offset:1024 sc1
    buffer_load_dwordx4 v[92:95], v156, s[4:7], s47 offen offset:2048 sc1
    buffer_load_dwordx4 v[96:99], v156, s[4:7], s47 offen offset:3072 sc1
L_nopend_112:
    s_add_u32 s54, s44, 3
    s_mov_b32 s55, 0x40000
L_afp_111:
    ds_read_b32 v161, v165
    ds_read_b128 v[132:135], v3
    s_waitcnt lgkmcnt(0)
    v_cmp_gt_u32 vcc, s54, v161
    s_cmp_eq_u64 vcc, 0
    s_cbranch_scc1 L_rd_110
    s_sleep 2
    s_sub_u32 s55, s55, 1
    s_cbranch_scc0 L_afp_111
L_rd_110:
    s_add_u32 s63, s44, 1
    s_waitcnt vmcnt(5)
    s_cmp_eq_u32 s49, 2
    s_cbranch_scc1 L_w4_113
    s_waitcnt vmcnt(4)
    s_cmp_eq_u32 s49, 1
    s_cbranch_scc1 L_w4_113
    s_waitcnt vmcnt(0)
L_w4_113:
    s_mov_b32 s49, 0
    s_cmp_eq_u32 s59, 0
    s_cbranch_scc1 L_nosig_114
    s_mov_b32 s59, 0
    v_mov_b32 v1, 161828
    s_mov_b64 exec, 1
    ds_add_rtn_u32 v3, v1, v167
    s_waitcnt lgkmcnt(0)
    v_readfirstlane_b32 s46, v3
    s_mov_b64 exec, -1
    s_cmp_lg_u32 s46, 3
    s_cbranch_scc1 L_nosig_114
    s_lshl_b32 s46, s2, 7
    s_add_u32 s46, s46, 36864
    v_mov_b32 v1, 0
    v_mov_b32 v3, s43
    s_mov_b64 exec, 1
    buffer_store_dword v3, v1, s[4:7], s46 offen sc1
    s_mov_b64 exec, -1
L_nosig_114:
    s_cmp_eq_u32 s56, s44
    s_cbranch_scc1 L_hook_115
    s_add_u32 s47, s41, s63
    s_and_b32 s47, s47, 7
    s_lshl_b32 s47, s47, 2
    s_add_u32 s47, s47, s45
    s_lshl_b32 s47, s47, 14
    s_add_u32 s47, s47, 524288
    v_smfmac_f32_16x16x64_bf16 v[4:7], v[132:135], v[36:43], v157
    v_smfmac_f32_16x16x64_bf16 v[8:11], v[132:135], v[44:51], v157
    buffer_load_dwordx4 v[36:39], v156, s[4:7], s47 offen offset:0 sc1
    buffer_load_dwordx4 v[40:43], v156, s[4:7], s47 offen offset:1024 sc1
    v_smfmac_f32_16x16x64_bf16 v[12:15], v[132:135], v[52:59], v157
    buffer_load_dwordx4 v[44:47], v156, s[4:7], s47 offen offset:2048 sc1
    buffer_load_dwordx4 v[48:51], v156, s[4:7], s47 offen offset:3072 sc1
    v_smfmac_f32_16x16x64_bf16 v[16:19], v[132:135], v[60:67], v157
    s_add_u32 s47, s47, 4096
    buffer_load_dwordx4 v[52:55], v156, s[4:7], s47 offen offset:0 sc1
    buffer_load_dwordx4 v[56:59], v156, s[4:7], s47 offen offset:1024 sc1
    v_smfmac_f32_16x16x64_bf16 v[20:23], v[132:135], v[68:75], v157
    buffer_load_dwordx4 v[60:63], v156, s[4:7], s47 offen offset:2048 sc1
    buffer_load_dwordx4 v[64:67], v156, s[4:7], s47 offen offset:3072 sc1
    v_smfmac_f32_16x16x64_bf16 v[24:27], v[132:135], v[76:83], v157
    v_smfmac_f32_16x16x64_bf16 v[28:31], v[132:135], v[84:91], v157
    v_smfmac_f32_16x16x64_bf16 v[32:35], v[132:135], v[92:99], v157
    s_mov_b32 s58, s47
    s_mov_b32 s57, 1
L_next_116:
    s_add_u32 s44, s44, 1
    s_branch L_op
H_hk:
    s_setpc_b64 s[100:101]
L_hook_115:
    v_smfmac_f32_16x16x64_bf16 v[4:7], v[132:135], v[36:43], v157
    v_smfmac_f32_16x16x64_bf16 v[8:11], v[132:135], v[44:51], v157
    v_smfmac_f32_16x16x64_bf16 v[12:15], v[132:135], v[52:59], v157
    v_smfmac_f32_16x16x64_bf16 v[16:19], v[132:135], v[60:67], v157
    v_smfmac_f32_16x16x64_bf16 v[20:23], v[132:135], v[68:75], v157
    v_smfmac_f32_16x16x64_bf16 v[24:27], v[132:135], v[76:83], v157
    v_smfmac_f32_16x16x64_bf16 v[28:31], v[132:135], v[84:91], v157
    v_smfmac_f32_16x16x64_bf16 v[32:35], v[132:135], v[92:99], v157
    s_mov_b32 s56, 9
    s_cmp_eq_u32 s45, 3
    s_cbranch_scc1 L_ep_117
    v_and_b32 v148, 31, v0
    v_lshrrev_b32 v149, 5, v0
    s_lshl_b32 s50, s45, 10
    s_add_u32 s50, s50, s90
    s_lshl_b32 s46, s41, 12
    s_add_u32 s46, s46, 36864
    v_lshl_add_u32 v161, v0, 7, s46
    s_mov_b64 exec, 0xffffffff
    buffer_load_dword v162, v161, s[4:7], 0 offen sc1
    s_mov_b64 exec, -1
    s_getpc_b64 s[96:97]
L_pc_119:
    s_add_u32 s96, s96, dft_tab+4096-L_pc_119
    s_addc_u32 s97, s97, 0
    s_lshl_b32 s46, s45, 13
    s_add_u32 s96, s96, s46
    s_addc_u32 s97, s97, 0
    global_load_dwordx4 v[68:71], v156, s[96:97] offset:0
    global_load_dwordx4 v[72:75], v156, s[96:97] offset:1024
    global_load_dwordx4 v[76:79], v156, s[96:97] offset:2048
    global_load_dwordx4 v[80:83], v156, s[96:97] offset:3072
    s_add_u32 s96, s96, 4096
    s_addc_u32 s97, s97, 0
    global_load_dwordx4 v[84:87], v156, s[96:97] offset:0
    global_load_dwordx4 v[88:91], v156, s[96:97] offset:1024
    global_load_dwordx4 v[92:95], v156, s[96:97] offset:2048
    global_load_dwordx4 v[96:99], v156, s[96:97] offset:3072
    s_mov_b64 exec, 0xffffffff
    s_waitcnt vmcnt(8)
    s_mov_b32 s55, 0x20000
L_gp_120:
    v_cmp_ne_u32 vcc, s43, v162
    s_cmp_eq_u64 vcc, 0
    s_cbranch_scc1 L_gpd_121
    s_sleep 4
    buffer_load_dword v162, v161, s[4:7], 0 offen sc1
    s_waitcnt vmcnt(0)
    s_sub_u32 s55, s55, 1
    s_cbranch_scc0 L_gp_120
L_gpd_121:
    s_mov_b64 exec, -1
    s_lshl_b32 s46, s90, 3
    s_add_u32 s46, s46, s41
    s_lshl_b32 s46, s46, 13
    s_add_u32 s46, s46, 4718592
    buffer_load_dwordx4 v[36:39], v156, s[4:7], s46 offen offset:0 sc1
    buffer_load_dwordx4 v[40:43], v156, s[4:7], s46 offen offset:1024 sc1
    buffer_load_dwordx4 v[44:47], v156, s[4:7], s46 offen offset:2048 sc1
    buffer_load_dwordx4 v[48:51], v156, s[4:7], s46 offen offset:3072 sc1
    s_add_u32 s46, s46, 4096
    buffer_load_dwordx4 v[52:55], v156, s[4:7], s46 offen offset:0 sc1
    buffer_load_dwordx4 v[56:59], v156, s[4:7], s46 offen offset:1024 sc1
    buffer_load_dwordx4 v[60:63], v156, s[4:7], s46 offen offset:2048 sc1
    buffer_load_dwordx4 v[64:67], v156, s[4:7], s46 offen offset:3072 sc1
    s_cmp_lg_u32 s41, 7
    s_cbranch_scc1 L_noe0a_122
    v_lshlrev_b32 v3, 7, v0
    s_lshl_b32 s46, s90, 2
    s_add_u32 s46, s46, 327680
    buffer_load_dword v150, v3, s[4:7], s46 offen sc1
L_noe0a_122:
    s_lshl_b32 s47, s45, 13
    s_add_u32 s47, s47, 65536
    v_add_u32 v161, s47, v156
    v_bfe_u32 v3, v0, 2, 2
    v_lshl_add_u32 v3, v149, 3, v3
    v_lshlrev_b32 v3, 6, v3
    v_bfe_u32 v162, v0, 4, 1
    v_lshl_add_u32 v3, v162, 5, v3
    v_and_b32 v162, 3, v0
    v_lshl_add_u32 v3, v162, 3, v3
    v_add_u32 v3, s47, v3
    s_waitcnt vmcnt(0)
    ds_write_b128 v161, v[36:39] offset:0
    ds_write_b128 v161, v[40:43] offset:1024
    ds_write_b128 v161, v[44:47] offset:2048
    ds_write_b128 v161, v[48:51] offset:3072
    ds_write_b128 v161, v[52:55] offset:4096
    ds_write_b128 v161, v[56:59] offset:5120
    ds_write_b128 v161, v[60:63] offset:6144
    ds_write_b128 v161, v[64:67] offset:7168
    s_waitcnt lgkmcnt(0)
    ds_read_b64_tr_b16 v[36:37], v3 offset:0
    ds_read_b64_tr_b16 v[38:39], v3 offset:256
    ds_read_b64_tr_b16 v[40:41], v3 offset:1024
    ds_read_b64_tr_b16 v[42:43], v3 offset:1280
    ds_read_b64_tr_b16 v[44:45], v3 offset:2048
    ds_read_b64_tr_b16 v[46:47], v3 offset:2304
    ds_read_b64_tr_b16 v[48:49], v3 offset:3072
    ds_read_b64_tr_b16 v[50:51], v3 offset:3328
    s_waitcnt lgkmcnt(0)
    ds_read_b64_tr_b16 v[52:53], v3 offset:4096
    ds_read_b64_tr_b16 v[54:55], v3 offset:4352
    ds_read_b64_tr_b16 v[56:57], v3 offset:5120
    ds_read_b64_tr_b16 v[58:59], v3 offset:5376
    ds_read_b64_tr_b16 v[60:61], v3 offset:6144
    ds_read_b64_tr_b16 v[62:63], v3 offset:6400
    ds_read_b64_tr_b16 v[64:65], v3 offset:7168
    ds_read_b64_tr_b16 v[66:67], v3 offset:7424
    v_mfma_f32_32x32x16_bf16 v[100:115], v[36:39], v[68:71], 0
    s_sleep 1
    v_mfma_f32_32x32x16_bf16 v[100:115], v[40:43], v[72:75], v[100:115]
    s_sleep 1
    v_mfma_f32_32x32x16_bf16 v[100:115], v[44:47], v[76:79], v[100:115]
    s_sleep 1
    v_mfma_f32_32x32x16_bf16 v[100:115], v[48:51], v[80:83], v[100:115]
    s_sleep 1
    s_waitcnt lgkmcnt(0)
    v_mfma_f32_32x32x16_bf16 v[100:115], v[52:55], v[84:87], v[100:115]
    s_sleep 1
    v_mfma_f32_32x32x16_bf16 v[100:115], v[56:59], v[88:91], v[100:115]
    s_sleep 1
    v_mfma_f32_32x32x16_bf16 v[100:115], v[60:63], v[92:95], v[100:115]
    s_sleep 1
    v_mfma_f32_32x32x16_bf16 v[100:115], v[64:67], v[96:99], v[100:115]
    s_sleep 1
    s_branch H_h2_skip
H_h2:
    s_setpc_b64 s[100:101]
H_h2_skip:
    s_lshl_b32 s47, s45, 13
    s_add_u32 s47, s47, 65536
    v_and_b32 v3, 7, v148
    v_lshlrev_b32 v161, 1, v149
    v_xor_b32 v161, v161, v3
    v_lshl_add_u32 v1, v148, 7, s47
    s_nop 5
    v_cvt_pk_bf16_f32 v116, v100, v101
    v_cvt_pk_bf16_f32 v117, v102, v103
    v_cvt_pk_bf16_f32 v118, v104, v105
    v_cvt_pk_bf16_f32 v119, v106, v107
    v_cvt_pk_bf16_f32 v120, v108, v109
    v_cvt_pk_bf16_f32 v121, v110, v111
    v_cvt_pk_bf16_f32 v122, v112, v113
    v_cvt_pk_bf16_f32 v123, v114, v115
    v_cvt_pk_bf16_f32 v124, v115, v114
    v_cvt_pk_bf16_f32 v125, v113, v112
    v_cvt_pk_bf16_f32 v126, v111, v110
    v_cvt_pk_bf16_f32 v127, v109, v108
    v_cvt_pk_bf16_f32 v128, v107, v106
    v_cvt_pk_bf16_f32 v129, v105, v104
    v_cvt_pk_bf16_f32 v130, v103, v102
    v_cvt_pk_bf16_f32 v131, v101, v100
    v_xor_b32 v3, 0, v161
    v_lshl_add_u32 v3, v3, 4, v1
    ds_write_b128 v3, v[116:119]
    v_xor_b32 v3, 1, v161
    v_lshl_add_u32 v3, v3, 4, v1
    ds_write_b128 v3, v[120:123]
    v_xor_b32 v3, 6, v161
    v_lshl_add_u32 v3, v3, 4, v1
    ds_write_b128 v3, v[124:127]
    v_xor_b32 v3, 7, v161
    v_lshl_add_u32 v3, v3, 4, v1
    ds_write_b128 v3, v[128:131]
    v_lshrrev_b32 v161, 2, v0
    v_and_b32 v3, 3, v0
    v_and_b32 v1, 7, v161
    v_xor_b32 v1, v1, v3
    v_lshlrev_b32 v1, 4, v1
    v_lshl_add_u32 v1, v161, 7, v1
    v_add_u32 v1, s47, v1
    v_xor_b32 v162, 64, v1
    s_waitcnt lgkmcnt(0)
    ds_read_b128 v[116:119], v1
    ds_read_b128 v[120:123], v1 offset:2048
    ds_read_b128 v[124:127], v162
    ds_read_b128 v[128:131], v162 offset:2048
    v_lshlrev_b32 v3, 4, v3
    v_lshl_add_u32 v1, v161, 16, v3
    s_lshl_b32 s46, s50, 11
    s_lshl_b32 s47, s41, 6
    s_add_u32 s51, s46, s47
    s_add_u32 s51, s51, 1026
    s_add_u32 s52, s51, 0x100000
    v_lshlrev_b32 v161, 5, v161
    s_sub_u32 s46, 2048, s50
    v_sub_u32 v161, s46, v161
    s_sub_u32 s47, 1984, s47
    v_add_u32 v3, s47, v3
    v_subrev_u32 v162, 512, v161
    v_and_b32 v161, 2047, v161
    v_lshl_add_u32 v161, v161, 11, v3
    v_and_b32 v162, 2047, v162
    v_lshl_add_u32 v162, v162, 11, v3
    s_waitcnt lgkmcnt(0)
    v_mov_b32 v151, v1
    v_mov_b32 v152, v161
    s_cmp_lg_u32 s41, 7
    s_cbranch_scc1 L_noe0b_123
    s_lshl_b32 s46, s45, 8
    s_add_u32 s46, s46, 81920
    v_lshl_add_u32 v3, v0, 1, s46
    v_lshl_add_u32 v1, v149, 4, s46
    ds_write_b16 v3, v150
    ds_write_b16_d16_hi v3, v150 offset:128
    ds_read_b128 v[36:39], v1 offset:0
    ds_read_b128 v[40:43], v1 offset:32
    ds_read_b128 v[44:47], v1 offset:64
    ds_read_b128 v[48:51], v1 offset:96
    ds_read_b128 v[52:55], v1 offset:128
    ds_read_b128 v[56:59], v1 offset:160
    ds_read_b128 v[60:63], v1 offset:192
    ds_read_b128 v[64:67], v1 offset:224
    s_waitcnt lgkmcnt(0)
    v_mfma_f32_32x32x16_bf16 v[100:115], v[36:39], v[68:71], 0
    s_sleep 1
    v_mfma_f32_32x32x16_bf16 v[100:115], v[40:43], v[72:75], v[100:115]
    s_sleep 1
    v_mfma_f32_32x32x16_bf16 v[100:115], v[44:47], v[76:79], v[100:115]
    s_sleep 1
    v_mfma_f32_32x32x16_bf16 v[100:115], v[48:51], v[80:83], v[100:115]
    s_sleep 1
    v_mfma_f32_32x32x16_bf16 v[100:115], v[52:55], v[84:87], v[100:115]
    s_sleep 1
    v_mfma_f32_32x32x16_bf16 v[100:115], v[56:59], v[88:91], v[100:115]
    s_sleep 1
    v_mfma_f32_32x32x16_bf16 v[100:115], v[60:63], v[92:95], v[100:115]
    s_sleep 1
    v_mfma_f32_32x32x16_bf16 v[100:115], v[64:67], v[96:99], v[100:115]
    s_sleep 1
    v_lshlrev_b32 v3, 16, v148
    s_lshl_b32 s46, s50, 11
    s_add_u32 s46, s46, 1024
    s_nop 7
    s_nop 1
    v_cvt_pk_bf16_f32 v161, v100, v100
    s_mov_b32 s48, s46
L_noe0b_123:
    s_add_u32 s47, s41, s63
    s_and_b32 s47, s47, 7
    s_lshl_b32 s47, s47, 2
    s_add_u32 s47, s47, s45
    s_lshl_b32 s47, s47, 14
    s_add_u32 s47, s47, 524288
    buffer_load_dwordx4 v[36:39], v156, s[4:7], s47 offen offset:0 sc1
    buffer_load_dwordx4 v[40:43], v156, s[4:7], s47 offen offset:1024 sc1
    buffer_load_dwordx4 v[44:47], v156, s[4:7], s47 offen offset:2048 sc1
    buffer_load_dwordx4 v[48:51], v156, s[4:7], s47 offen offset:3072 sc1
    s_add_u32 s47, s47, 4096
    buffer_load_dwordx4 v[52:55], v156, s[4:7], s47 offen offset:0 sc1
    buffer_load_dwordx4 v[56:59], v156, s[4:7], s47 offen offset:1024 sc1
    buffer_load_dwordx4 v[60:63], v156, s[4:7], s47 offen offset:2048 sc1
    buffer_load_dwordx4 v[64:67], v156, s[4:7], s47 offen offset:3072 sc1
    s_add_u32 s47, s47, 4096
    buffer_load_dwordx4 v[68:71], v156, s[4:7], s47 offen offset:0 sc1
    buffer_load_dwordx4 v[72:75], v156, s[4:7], s47 offen offset:1024 sc1
    buffer_load_dwordx4 v[76:79], v156, s[4:7], s47 offen offset:2048 sc1
    buffer_load_dwordx4 v[80:83], v156, s[4:7], s47 offen offset:3072 sc1
    s_add_u32 s47, s47, 4096
    buffer_load_dwordx4 v[84:87], v156, s[4:7], s47 offen offset:0 sc1
    buffer_load_dwordx4 v[88:91], v156, s[4:7], s47 offen offset:1024 sc1
    buffer_load_dwordx4 v[92:95], v156, s[4:7], s47 offen offset:2048 sc1
    buffer_load_dwordx4 v[96:99], v156, s[4:7], s47 offen offset:3072 sc1
    buffer_store_dwordx4 v[116:119], v151, s[24:27], s51 offen sc1
    buffer_store_dwordx4 v[120:123], v151, s[24:27], s52 offen sc1
    buffer_store_dwordx4 v[124:127], v152, s[24:27], 0 offen sc1
    buffer_store_dwordx4 v[128:131], v162, s[24:27], 0 offen sc1
    s_mov_b32 s49, 1
    s_cmp_lg_u32 s41, 7
    s_cbranch_scc1 L_noe0c_124
    s_mov_b32 s49, 2
    s_mov_b32 exec_hi, 0
    buffer_store_short v161, v3, s[24:27], s48 offen sc1
    s_mov_b32 exec_hi, -1
L_noe0c_124:
    s_branch L_next_116
L_ep_117:
    v_lshlrev_b32 v3, 7, v0
    v_add_u32 v3, 36864, v3
    buffer_load_dword v1, v3, s[4:7], 0 offen sc1
    s_waitcnt vmcnt(0)
    s_mov_b32 s55, 0x20000
L_gp_125:
    v_cmp_ne_u32 vcc, s43, v1
    s_cmp_eq_u64 vcc, 0
    s_cbranch_scc1 L_gpd_126
    s_sleep 8
    buffer_load_dword v1, v3, s[4:7], 0 offen sc1
    s_waitcnt vmcnt(0)
    s_sub_u32 s55, s55, 1
    s_cbranch_scc0 L_gp_125
L_gpd_126:
    v_lshlrev_b32 v3, 7, v0
    v_add_u32 v3, 45056, v3
    buffer_load_dword v1, v3, s[4:7], 0 offen sc1
    s_waitcnt vmcnt(0)
    s_mov_b32 s55, 0x20000
L_gp_127:
    v_cmp_ne_u32 vcc, s43, v1
    s_cmp_eq_u64 vcc, 0
    s_cbranch_scc1 L_gpd_128
    s_sleep 8
    buffer_load_dword v1, v3, s[4:7], 0 offen sc1
    s_waitcnt vmcnt(0)
    s_sub_u32 s55, s55, 1
    s_cbranch_scc0 L_gp_127
L_gpd_128:
    v_lshlrev_b32 v3, 7, v0
    v_add_u32 v3, 53248, v3
    buffer_load_dword v1, v3, s[4:7], 0 offen sc1
    s_waitcnt vmcnt(0)
    s_mov_b32 s55, 0x20000
L_gp_129:
    v_cmp_ne_u32 vcc, s43, v1
    s_cmp_eq_u64 vcc, 0
    s_cbranch_scc1 L_gpd_130
    s_sleep 8
    buffer_load_dword v1, v3, s[4:7], 0 offen sc1
    s_waitcnt vmcnt(0)
    s_sub_u32 s55, s55, 1
    s_cbranch_scc0 L_gp_129
L_gpd_130:
    v_lshlrev_b32 v3, 7, v0
    v_add_u32 v3, 61440, v3
    buffer_load_dword v1, v3, s[4:7], 0 offen sc1
    s_waitcnt vmcnt(0)
    s_mov_b32 s55, 0x20000
L_gp_131:
    v_cmp_ne_u32 vcc, s43, v1
    s_cmp_eq_u64 vcc, 0
    s_cbranch_scc1 L_gpd_132
    s_sleep 8
    buffer_load_dword v1, v3, s[4:7], 0 offen sc1
    s_waitcnt vmcnt(0)
    s_sub_u32 s55, s55, 1
    s_cbranch_scc0 L_gp_131
L_gpd_132:
    s_mov_b32 s46, 0
    v_mov_b32 v1, 0
    v_mov_b32 v3, s43
    s_mov_b64 exec, 1
    buffer_store_dword v3, v1, s[4:7], s46 offen sc1
    s_mov_b64 exec, -1
L_wo_118:
    s_add_u32 s47, s41, s63
    s_and_b32 s47, s47, 7
    s_lshl_b32 s47, s47, 2
    s_add_u32 s47, s47, s45
    s_lshl_b32 s47, s47, 14
    s_add_u32 s47, s47, 524288
    buffer_load_dwordx4 v[36:39], v156, s[4:7], s47 offen offset:0 sc1
    buffer_load_dwordx4 v[40:43], v156, s[4:7], s47 offen offset:1024 sc1
    buffer_load_dwordx4 v[44:47], v156, s[4:7], s47 offen offset:2048 sc1
    buffer_load_dwordx4 v[48:51], v156, s[4:7], s47 offen offset:3072 sc1
    s_add_u32 s47, s47, 4096
    buffer_load_dwordx4 v[52:55], v156, s[4:7], s47 offen offset:0 sc1
    buffer_load_dwordx4 v[56:59], v156, s[4:7], s47 offen offset:1024 sc1
    buffer_load_dwordx4 v[60:63], v156, s[4:7], s47 offen offset:2048 sc1
    buffer_load_dwordx4 v[64:67], v156, s[4:7], s47 offen offset:3072 sc1
    s_add_u32 s47, s47, 4096
    buffer_load_dwordx4 v[68:71], v156, s[4:7], s47 offen offset:0 sc1
    buffer_load_dwordx4 v[72:75], v156, s[4:7], s47 offen offset:1024 sc1
    buffer_load_dwordx4 v[76:79], v156, s[4:7], s47 offen offset:2048 sc1
    buffer_load_dwordx4 v[80:83], v156, s[4:7], s47 offen offset:3072 sc1
    s_add_u32 s47, s47, 4096
    buffer_load_dwordx4 v[84:87], v156, s[4:7], s47 offen offset:0 sc1
    buffer_load_dwordx4 v[88:91], v156, s[4:7], s47 offen offset:1024 sc1
    buffer_load_dwordx4 v[92:95], v156, s[4:7], s47 offen offset:2048 sc1
    buffer_load_dwordx4 v[96:99], v156, s[4:7], s47 offen offset:3072 sc1
    s_branch L_next_116
H_s7:
    s_setpc_b64 s[100:101]
L_s7_109:
    s_waitcnt lgkmcnt(0)
    s_barrier
    ds_read_b128 v[132:135], v3
    s_waitcnt vmcnt(0) lgkmcnt(0)
    v_smfmac_f32_16x16x64_bf16 v[4:7], v[132:135], v[36:43], v157
    v_smfmac_f32_16x16x64_bf16 v[8:11], v[132:135], v[44:51], v157
    v_smfmac_f32_16x16x64_bf16 v[12:15], v[132:135], v[52:59], v157
    v_smfmac_f32_16x16x64_bf16 v[16:19], v[132:135], v[60:67], v157
    v_smfmac_f32_16x16x64_bf16 v[20:23], v[132:135], v[68:75], v157
    v_smfmac_f32_16x16x64_bf16 v[24:27], v[132:135], v[76:83], v157
    v_smfmac_f32_16x16x64_bf16 v[28:31], v[132:135], v[84:91], v157
    v_smfmac_f32_16x16x64_bf16 v[32:35], v[132:135], v[92:99], v157
L_op_done:
    s_nop 0
    v_permlane32_swap_b32 v4, v6
    v_permlane32_swap_b32 v5, v7
    v_permlane32_swap_b32 v8, v10
    v_permlane32_swap_b32 v9, v11
    v_pk_add_f32 v[4:5], v[4:5], v[6:7]
    v_permlane32_swap_b32 v12, v14
    v_permlane32_swap_b32 v13, v15
    v_pk_add_f32 v[8:9], v[8:9], v[10:11]
    v_permlane32_swap_b32 v16, v18
    v_permlane32_swap_b32 v17, v19
    v_pk_add_f32 v[12:13], v[12:13], v[14:15]
    v_permlane32_swap_b32 v20, v22
    v_permlane32_swap_b32 v21, v23
    v_pk_add_f32 v[16:17], v[16:17], v[18:19]
    v_permlane32_swap_b32 v24, v26
    v_permlane32_swap_b32 v25, v27
    v_pk_add_f32 v[20:21], v[20:21], v[22:23]
    v_permlane32_swap_b32 v28, v30
    v_permlane32_swap_b32 v29, v31
    v_pk_add_f32 v[24:25], v[24:25], v[26:27]
    v_permlane32_swap_b32 v32, v34
    v_permlane32_swap_b32 v33, v35
    v_pk_add_f32 v[28:29], v[28:29], v[30:31]
    v_pk_add_f32 v[32:33], v[32:33], v[34:35]
    v_cvt_pk_bf16_f32 v100, v4, v8
    v_cvt_pk_bf16_f32 v101, v12, v16
    v_cvt_pk_bf16_f32 v102, v20, v24
    v_cvt_pk_bf16_f32 v103, v28, v32
    buffer_store_dwordx4 v[100:103], v163, s[24:27], s58 offen offset:0 sc1
    v_cvt_pk_bf16_f32 v104, v5, v9
    v_cvt_pk_bf16_f32 v105, v13, v17
    v_cvt_pk_bf16_f32 v106, v21, v25
    v_cvt_pk_bf16_f32 v107, v29, v33
    buffer_store_dwordx4 v[104:107], v163, s[24:27], s58 offen offset:2048 sc1
    s_lshl_b32 s46, s45, 2
    s_add_u32 s46, s46, 161856
    v_mov_b32 v3, s46
    v_add_f32 v161, v4, v5
    s_movk_i32 s46, 0x207
    v_cmp_class_f32_e64 vcc, v161, s46
    s_nop 1
    s_cmp_lg_u64 vcc, 0
    s_cselect_b32 s46, 1, 0
    s_cmp_lg_u32 s39, 0
    s_cselect_b32 s46, 0, s46
    v_mov_b32 v162, s46
    ds_write_b32 v3, v162
    s_waitcnt lgkmcnt(0)
    s_barrier
    s_cmp_lg_u32 s46, 0
    s_cbranch_scc0 L_end
L_aux_fb:
    s_waitcnt vmcnt(0)
    s_mov_b32 s39, 1
    s_mov_b32 s44, 0
    s_mov_b32 s63, 0
    v_mov_b32 v4, 0
    v_mov_b32 v5, 0
    v_mov_b32 v6, 0
    v_mov_b32 v7, 0
    v_mov_b32 v8, 0
    v_mov_b32 v9, 0
    v_mov_b32 v10, 0
    v_mov_b32 v11, 0
    v_mov_b32 v12, 0
    v_mov_b32 v13, 0
    v_mov_b32 v14, 0
    v_mov_b32 v15, 0
    v_mov_b32 v16, 0
    v_mov_b32 v17, 0
    v_mov_b32 v18, 0
    v_mov_b32 v19, 0
    v_mov_b32 v20, 0
    v_mov_b32 v21, 0
    v_mov_b32 v22, 0
    v_mov_b32 v23, 0
    v_mov_b32 v24, 0
    v_mov_b32 v25, 0
    v_mov_b32 v26, 0
    v_mov_b32 v27, 0
    v_mov_b32 v28, 0
    v_mov_b32 v29, 0
    v_mov_b32 v30, 0
    v_mov_b32 v31, 0
    v_mov_b32 v32, 0
    v_mov_b32 v33, 0
    v_mov_b32 v34, 0
    v_mov_b32 v35, 0
    s_add_u32 s47, s41, s63
    s_and_b32 s47, s47, 7
    s_lshl_b32 s47, s47, 2
    s_add_u32 s47, s47, s45
    s_lshl_b32 s47, s47, 14
    s_add_u32 s47, s47, 524288
    buffer_load_dwordx4 v[36:39], v156, s[4:7], s47 offen offset:0 sc1
    buffer_load_dwordx4 v[40:43], v156, s[4:7], s47 offen offset:1024 sc1
    buffer_load_dwordx4 v[44:47], v156, s[4:7], s47 offen offset:2048 sc1
    buffer_load_dwordx4 v[48:51], v156, s[4:7], s47 offen offset:3072 sc1
    s_add_u32 s47, s47, 4096
    buffer_load_dwordx4 v[52:55], v156, s[4:7], s47 offen offset:0 sc1
    buffer_load_dwordx4 v[56:59], v156, s[4:7], s47 offen offset:1024 sc1
    buffer_load_dwordx4 v[60:63], v156, s[4:7], s47 offen offset:2048 sc1
    buffer_load_dwordx4 v[64:67], v156, s[4:7], s47 offen offset:3072 sc1
    s_add_u32 s47, s47, 4096
    buffer_load_dwordx4 v[68:71], v156, s[4:7], s47 offen offset:0 sc1
    buffer_load_dwordx4 v[72:75], v156, s[4:7], s47 offen offset:1024 sc1
    buffer_load_dwordx4 v[76:79], v156, s[4:7], s47 offen offset:2048 sc1
    buffer_load_dwordx4 v[80:83], v156, s[4:7], s47 offen offset:3072 sc1
    s_add_u32 s47, s47, 4096
    buffer_load_dwordx4 v[84:87], v156, s[4:7], s47 offen offset:0 sc1
    buffer_load_dwordx4 v[88:91], v156, s[4:7], s47 offen offset:1024 sc1
    buffer_load_dwordx4 v[92:95], v156, s[4:7], s47 offen offset:2048 sc1
    buffer_load_dwordx4 v[96:99], v156, s[4:7], s47 offen offset:3072 sc1
    s_barrier
    s_barrier
    s_barrier
    s_branch L_op
L_end:
    s_endpgm
.p2align 7
.type dft_tab,@object
dft_tab:
.quad 0x3f803f803f803f80,0x3f803f803f803f80,0x3f553f6d3f7b3f80,0x3e483ec43f0e3f35
.quad 0x3ec43f353f6d3f80,0xbf6dbf35bec4248d,0xbe483ec43f553f80,0xbf0ebf6dbf7bbf35
.quad 0xbf35248d3f353f80,0x3f35a554bf35bf80,0xbf7bbec43f0e3f80,0x3f553f6d3e48bf35
.quad 0xbf6dbf353ec43f80,0xbec43f353f6da554,0xbf0ebf6d3e483f80,0xbf7bbec43f553f35
.quad 0xa554bf80248d3f80,0xa554bf80248d3f80,0x3f0ebf6dbe483f80,0x3f7bbec4bf553f35
.quad 0x3f6dbf35bec43f80,0x3ec43f35bf6d248d,0x3f7bbec4bf0e3f80,0xbf553f6dbe48bf35
.quad 0x3f35a554bf353f80,0xbf35248d3f35bf80,0x3e483ec4bf553f80,0x3f0ebf6d3f7bbf35
.quad 0xbec43f35bf6d3f80,0x3f6dbf353ec4a554,0xbf553f6dbf7b3f80,0xbe483ec4bf0e3f35
.quad 0xbf803f80bf803f80,0xbf803f80bf803f80,0xbf553f6dbf7b3f80,0xbe483ec4bf0e3f35
.quad 0xbec43f35bf6d3f80,0x3f6dbf353ec4248d,0x3e483ec4bf553f80,0x3f0ebf6d3f7bbf35
.quad 0x3f35248dbf353f80,0xbf35a5543f35bf80,0x3f7bbec4bf0e3f80,0xbf553f6dbe48bf35
.quad 0x3f6dbf35bec43f80,0x3ec43f35bf6da554,0x3f0ebf6dbe483f80,0x3f7bbec4bf553f35
.quad 0x248dbf80a5543f80,0x248dbf80a5543f80,0xbf0ebf6d3e483f80,0xbf7bbec43f553f35
.quad 0xbf6dbf353ec43f80,0xbec43f353f6d248d,0xbf7bbec43f0e3f80,0x3f553f6d3e48bf35
.quad 0xbf35a5543f353f80,0x3f35248dbf35bf80,0xbe483ec43f553f80,0xbf0ebf6dbf7bbf35
.quad 0x3ec43f353f6d3f80,0xbf6dbf35bec4a554,0x3f553f6d3f7b3f80,0x3e483ec43f0e3f35
.quad 0x3f803f803f803f80,0x3f803f803f803f80,0xbf0ebec4be48248d,0xbf7bbf6dbf55bf35
.quad 0xbec4bf35bf6dbf80,0x3f6d3f353ec4a554,0x3f7b3f6d3f0ea554,0xbf55bec43e483f35
.quad 0xbf35248d3f353f80,0x3f35a554bf35bf80,0xbe48bf6dbf55248d,0xbf0e3ec43f7b3f35
.quad 0x3f6d3f35bec4bf80,0x3ec4bf35bf6d248d,0xbf553ec43f7ba554,0xbe483f6d3f0ebf35
.quad 0xa554bf80248d3f80,0xa554bf80248d3f80,0x3f553ec4bf7b248d,0x3e483f6dbf0ebf35
.quad 0xbf6d3f353ec4bf80,0xbec4bf353f6da554,0x3e48bf6d3f55a554,0x3f0e3ec4bf7b3f35
.quad 0x3f35a554bf353f80,0xbf35248d3f35bf80,0xbf7b3f6dbf0e248d,0x3f55bec4be483f35
.quad 0x3ec4bf353f6dbf80,0xbf6d3f35bec4248d,0x3f0ebec43e48a554,0x3f7bbf6d3f55bf35
.quad 0xbf803f80bf803f80,0xbf803f80bf803f80,0x3f0ebec43e48248d,0x3f7bbf6d3f55bf35
.quad 0x3ec4bf353f6dbf80,0xbf6d3f35bec4a554,0xbf7b3f6dbf0ea554,0x3f55bec4be483f35
.quad 0x3f35248dbf353f80,0xbf35a5543f35bf80,0x3e48bf6d3f55248d,0x3f0e3ec4bf7b3f35
.quad 0xbf6d3f353ec4bf80,0xbec4bf353f6d248d,0x3f553ec4bf7ba554,0x3e483f6dbf0ebf35
.quad 0x248dbf80a5543f80,0x248dbf80a5543f80,0xbf553ec43f7b248d,0xbe483f6d3f0ebf35
.quad 0x3f6d3f35bec4bf80,0x3ec4bf35bf6da554,0xbe48bf6dbf55a554,0xbf0e3ec43f7b3f35
.quad 0xbf35a5543f353f80,0x3f35248dbf35bf80,0x3f7b3f6d3f0e248d,0xbf55bec43e483f35
.quad 0xbec4bf35bf6dbf80,0x3f6d3f353ec4248d,0xbf0ebec4be48a554,0xbf7bbf6dbf55bf35
.quad 0x3f803f803f803f80,0x3f803f803f803f80,0xbf55bf6dbf7bbf80,0xbe48bec4bf0ebf35
.quad 0x3ec43f353f6d3f80,0xbf6dbf35bec4248d,0x3e48bec4bf55bf80,0x3f0e3f6d3f7b3f35
.quad 0xbf35248d3f353f80,0x3f35a554bf35bf80,0x3f7b3ec4bf0ebf80,0xbf55bf6dbe483f35
.quad 0xbf6dbf353ec43f80,0xbec43f353f6da554,0x3f0e3f6dbe48bf80,0x3f7b3ec4bf55bf35
.quad 0xa554bf80248d3f80,0xa554bf80248d3f80,0xbf0e3f6d3e48bf80,0xbf7b3ec43f55bf35
.quad 0x3f6dbf35bec43f80,0x3ec43f35bf6d248d,0xbf7b3ec43f0ebf80,0x3f55bf6d3e483f35
.quad 0x3f35a554bf353f80,0xbf35248d3f35bf80,0xbe48bec43f55bf80,0xbf0e3f6dbf7b3f35
.quad 0xbec43f35bf6d3f80,0x3f6dbf353ec4a554,0x3f55bf6d3f7bbf80,0x3e48bec43f0ebf35
.quad 0xbf803f80bf803f80,0xbf803f80bf803f80,0x3f55bf6d3f7bbf80,0x3e48bec43f0ebf35
.quad 0xbec43f35bf6d3f80,0x3f6dbf353ec4248d,0xbe48bec43f55bf80,0xbf0e3f6dbf7b3f35
.quad 0x3f35248dbf353f80,0xbf35a5543f35bf80,0xbf7b3ec43f0ebf80,0x3f55bf6d3e483f35
.quad 0x3f6dbf35bec43f80,0x3ec43f35bf6da554,0xbf0e3f6d3e48bf80,0xbf7b3ec43f55bf35
.quad 0x248dbf80a5543f80,0x248dbf80a5543f80,0x3f0e3f6dbe48bf80,0x3f7b3ec4bf55bf35
.quad 0xbf6dbf353ec43f80,0xbec43f353f6d248d,0x3f7b3ec4bf0ebf80,0xbf55bf6dbe483f35
.quad 0xbf35a5543f353f80,0x3f35248dbf35bf80,0x3e48bec4bf55bf80,0x3f0e3f6d3f7b3f35
.quad 0x3ec43f353f6d3f80,0xbf6dbf35bec4a554,0xbf55bf6dbf7bbf80,0xbe48bec4bf0ebf35
.quad 0x3f803f803f803f80,0x3f803f803f803f80,0x3f0e3ec43e48a554,0x3f7b3f6d3f553f35
.quad 0xbec4bf35bf6dbf80,0x3f6d3f353ec4a554,0xbf7bbf6dbf0e248d,0x3f553ec4be48bf35
.quad 0xbf35248d3f353f80,0x3f35a554bf35bf80,0x3e483f6d3f55a554,0x3f0ebec4bf7bbf35
.quad 0x3f6d3f35bec4bf80,0x3ec4bf35bf6d248d,0x3f55bec4bf7b248d,0x3e48bf6dbf0e3f35
.quad 0xa554bf80248d3f80,0xa554bf80248d3f80,0xbf55bec43f7ba554,0xbe48bf6d3f0e3f35
.quad 0xbf6d3f353ec4bf80,0xbec4bf353f6da554,0xbe483f6dbf55248d,0xbf0ebec43f7bbf35
.quad 0x3f35a554bf353f80,0xbf35248d3f35bf80,0x3f7bbf6d3f0ea554,0xbf553ec43e48bf35
.quad 0x3ec4bf353f6dbf80,0xbf6d3f35bec4248d,0xbf0e3ec4be48248d,0xbf7b3f6dbf553f35
.quad 0xbf803f80bf803f80,0xbf803f80bf803f80,0xbf0e3ec4be48a554,0xbf7b3f6dbf553f35
.quad 0x3ec4bf353f6dbf80,0xbf6d3f35bec4a554,0x3f7bbf6d3f0e248d,0xbf553ec43e48bf35
.quad 0x3f35248dbf353f80,0xbf35a5543f35bf80,0xbe483f6dbf55a554,0xbf0ebec43f7bbf35
.quad 0xbf6d3f353ec4bf80,0xbec4bf353f6d248d,0xbf55bec43f7b248d,0xbe48bf6d3f0e3f35
.quad 0x248dbf80a5543f80,0x248dbf80a5543f80,0x3f55bec4bf7ba554,0x3e48bf6dbf0e3f35
.quad 0x3f6d3f35bec4bf80,0x3ec4bf35bf6da554,0x3e483f6d3f55248d,0x3f0ebec4bf7bbf35
.quad 0xbf35a5543f353f80,0x3f35248dbf35bf80,0xbf7bbf6dbf0ea554,0x3f553ec4be48bf35
.quad 0xbec4bf35bf6dbf80,0x3f6d3f353ec4248d,0x3f0e3ec43e48248d,0x3f7b3f6d3f553f35
.quad 0x8000800080008000,0x8000800080008000,0xbf0ebec4be488000,0xbf7bbf6dbf55bf35
.quad 0xbf6dbf35bec48000,0xbec4bf35bf6dbf80,0xbf7bbf6dbf0e8000,0x3f553ec4be48bf35
.quad 0xbf35bf80bf358000,0x3f353f803f35a50d,0xbe48bf6dbf558000,0xbf0e3ec43f7b3f35
.quad 0x3ec4bf35bf6d8000,0xbf6dbf353ec43f80,0x3f55bec4bf7b8000,0x3e48bf6dbf0e3f35
.quad 0x3f80a50dbf808000,0x3f80a50dbf808000,0x3f553ec4bf7b8000,0x3e483f6dbf0ebf35
.quad 0x3ec43f35bf6d8000,0xbf6d3f353ec4bf80,0xbe483f6dbf558000,0xbf0ebec43f7bbf35
.quad 0xbf353f80bf358000,0x3f35bf803f35a50d,0xbf7b3f6dbf0e8000,0x3f55bec4be483f35
.quad 0xbf6d3f35bec48000,0xbec43f35bf6d3f80,0xbf0e3ec4be488000,0xbf7b3f6dbf553f35
.quad 0xa50d8000a50d8000,0xa50d8000a50d8000,0x3f0ebec43e488000,0x3f7bbf6d3f55bf35
.quad 0x3f6dbf353ec48000,0x3ec4bf353f6dbf80,0x3f7bbf6d3f0e8000,0xbf553ec43e48bf35
.quad 0x3f35bf803f358000,0xbf353f80bf35a50d,0x3e48bf6d3f558000,0x3f0e3ec4bf7b3f35
.quad 0xbec4bf353f6d8000,0x3f6dbf35bec43f80,0xbf55bec43f7b8000,0xbe48bf6d3f0e3f35
.quad 0xbf80a50d3f808000,0xbf80a50d3f808000,0xbf553ec43f7b8000,0xbe483f6d3f0ebf35
.quad 0xbec43f353f6d8000,0x3f6d3f35bec4bf80,0x3e483f6d3f558000,0x3f0ebec4bf7bbf35
.quad 0x3f353f803f358000,0xbf35bf80bf35a50d,0x3f7b3f6d3f0e8000,0xbf55bec43e483f35
.quad 0x3f6d3f353ec48000,0x3ec43f353f6d3f80,0x3f0e3ec43e488000,0x3f7b3f6d3f553f35
.quad 0x8000800080008000,0x8000800080008000,0xbf55bf6dbf7bbf80,0xbe48bec4bf0ebf35
.quad 0x3f6d3f353ec4a50d,0x3ec43f353f6d3f80,0xbe483ec43f553f80,0xbf0ebf6dbf7bbf35
.quad 0xbf35bf80bf358000,0x3f353f803f35a50d,0x3f7b3ec4bf0ebf80,0xbf55bf6dbe483f35
.quad 0xbec43f353f6da50d,0x3f6d3f35bec4bf80,0xbf0ebf6d3e483f80,0xbf7bbec43f553f35
.quad 0x3f80a50dbf808000,0x3f80a50dbf808000,0xbf0e3f6d3e48bf80,0xbf7b3ec43f55bf35
.quad 0xbec4bf353f6da50d,0x3f6dbf35bec43f80,0x3f7bbec4bf0e3f80,0xbf553f6dbe48bf35
.quad 0xbf353f80bf358000,0x3f35bf803f35a50d,0xbe48bec43f55bf80,0xbf0e3f6dbf7b3f35
.quad 0x3f6dbf353ec4a50d,0x3ec4bf353f6dbf80,0xbf553f6dbf7b3f80,0xbe483ec4bf0e3f35
.quad 0xa50d8000a50d8000,0xa50d8000a50d8000,0x3f55bf6d3f7bbf80,0x3e48bec43f0ebf35
.quad 0xbf6d3f35bec4a50d,0xbec43f35bf6d3f80,0x3e483ec4bf553f80,0x3f0ebf6d3f7bbf35
.quad 0x3f35bf803f358000,0xbf353f80bf35a50d,0xbf7b3ec43f0ebf80,0x3f55bf6d3e483f35
.quad 0x3ec43f35bf6da50d,0xbf6d3f353ec4bf80,0x3f0ebf6dbe483f80,0x3f7bbec4bf553f35
.quad 0xbf80a50d3f808000,0xbf80a50d3f808000,0x3f0e3f6dbe48bf80,0x3f7b3ec4bf55bf35
.quad 0x3ec4bf35bf6da50d,0xbf6dbf353ec43f80,0xbf7bbec43f0e3f80,0x3f553f6d3e48bf35
.quad 0x3f353f803f358000,0xbf35bf80bf35a50d,0x3e48bec4bf55bf80,0x3f0e3f6d3f7b3f35
.quad 0xbf6dbf35bec4a50d,0xbec4bf35bf6dbf80,0x3f553f6d3f7b3f80,0x3e483ec43f0e3f35
.quad 0x8000800080008000,0x8000800080008000,0x3f0e3ec43e48a50d,0x3f7b3f6d3f553f35
.quad 0xbf6dbf35bec48000,0xbec4bf35bf6dbf80,0x3f7b3f6d3f0ea50d,0xbf55bec43e483f35
.quad 0xbf35bf80bf358000,0x3f353f803f35a50d,0x3e483f6d3f55a50d,0x3f0ebec4bf7bbf35
.quad 0x3ec4bf35bf6d8000,0xbf6dbf353ec43f80,0xbf553ec43f7ba50d,0xbe483f6d3f0ebf35
.quad 0x3f80a50dbf808000,0x3f80a50dbf808000,0xbf55bec43f7ba50d,0xbe48bf6d3f0e3f35
.quad 0x3ec43f35bf6d8000,0xbf6d3f353ec4bf80,0x3e48bf6d3f55a50d,0x3f0e3ec4bf7b3f35
.quad 0xbf353f80bf358000,0x3f35bf803f35a50d,0x3f7bbf6d3f0ea50d,0xbf553ec43e48bf35
.quad 0xbf6d3f35bec48000,0xbec43f35bf6d3f80,0x3f0ebec43e48a50d,0x3f7bbf6d3f55bf35
.quad 0xa50d8000a50d8000,0xa50d8000a50d8000,0xbf0e3ec4be48a50d,0xbf7b3f6dbf553f35
.quad 0x3f6dbf353ec48000,0x3ec4bf353f6dbf80,0xbf7b3f6dbf0ea50d,0x3f55bec4be483f35
.quad 0x3f35bf803f358000,0xbf353f80bf35a50d,0xbe483f6dbf55a50d,0xbf0ebec43f7bbf35
.quad 0xbec4bf353f6d8000,0x3f6dbf35bec43f80,0x3f553ec4bf7ba50d,0x3e483f6dbf0ebf35
.quad 0xbf80a50d3f808000,0xbf80a50d3f808000,0x3f55bec4bf7ba50d,0x3e48bf6dbf0e3f35
.quad 0xbec43f353f6d8000,0x3f6d3f35bec4bf80,0xbe48bf6dbf55a50d,0xbf0e3ec43f7b3f35
.quad 0x3f353f803f358000,0xbf35bf80bf35a50d,0xbf7bbf6dbf0ea50d,0x3f553ec4be48bf35
.quad 0x3f6d3f353ec48000,0x3ec43f353f6d3f80,0xbf0ebec4be48a50d,0xbf7bbf6dbf55bf35
.quad 0x8000800080008000,0x8000800080008000,0x3f553f6d3f7b3f80,0x3e483ec43f0e3f35
.quad 0x3f6d3f353ec4a50d,0x3ec43f353f6d3f80,0x3e48bec4bf55bf80,0x3f0e3f6d3f7b3f35
.quad 0xbf35bf80bf358000,0x3f353f803f35a50d,0xbf7bbec43f0e3f80,0x3f553f6d3e48bf35
.quad 0xbec43f353f6da50d,0x3f6d3f35bec4bf80,0x3f0e3f6dbe48bf80,0x3f7b3ec4bf55bf35
.quad 0x3f80a50dbf808000,0x3f80a50dbf808000,0x3f0ebf6dbe483f80,0x3f7bbec4bf553f35
.quad 0xbec4bf353f6da50d,0x3f6dbf35bec43f80,0xbf7b3ec43f0ebf80,0x3f55bf6d3e483f35
.quad 0xbf353f80bf358000,0x3f35bf803f35a50d,0x3e483ec4bf553f80,0x3f0ebf6d3f7bbf35
.quad 0x3f6dbf353ec4a50d,0x3ec4bf353f6dbf80,0x3f55bf6d3f7bbf80,0x3e48bec43f0ebf35
.quad 0xa50d8000a50d8000,0xa50d8000a50d8000,0xbf553f6dbf7b3f80,0xbe483ec4bf0e3f35
.quad 0xbf6d3f35bec4a50d,0xbec43f35bf6d3f80,0xbe48bec43f55bf80,0xbf0e3f6dbf7b3f35
.quad 0x3f35bf803f358000,0xbf353f80bf35a50d,0x3f7bbec4bf0e3f80,0xbf553f6dbe48bf35
.quad 0x3ec43f35bf6da50d,0xbf6d3f353ec4bf80,0xbf0e3f6d3e48bf80,0xbf7b3ec43f55bf35
.quad 0xbf80a50d3f808000,0xbf80a50d3f808000,0xbf0ebf6d3e483f80,0xbf7bbec43f553f35
.quad 0x3ec4bf35bf6da50d,0xbf6dbf353ec43f80,0x3f7b3ec4bf0ebf80,0xbf55bf6dbe483f35
.quad 0x3f353f803f358000,0xbf35bf80bf35a50d,0xbe483ec43f553f80,0xbf0ebf6dbf7bbf35
.quad 0xbf6dbf35bec4a50d,0xbec4bf35bf6dbf80,0xbf55bf6dbf7bbf80,0xbe48bec4bf0ebf35
.quad 0x3f803f803f803f80,0x3f803f803f803f80,0x3f753f7b3f7f3f80,0x3f463f553f623f6d
.quad 0x3f553f6d3f7b3f80,0x3e483ec43f0e3f35,0x3f223f553f753f80,0xbef1be483dc93ec4
.quad 0x3ec43f353f6d3f80,0xbf6dbf35bec4248d,0x3dc93f0e3f623f80,0xbf75bf7bbf46bec4
.quad 0xbe483ec43f553f80,0xbf0ebf6dbf7bbf35,0xbef13e483f463f80,0x3dc9bf0ebf75bf6d
.quad 0xbf35248d3f353f80,0x3f35a554bf35bf80,0xbf62be483f223f80,0x3f7f3f0ebe95bf6d
.quad 0xbf7bbec43f0e3f80,0x3f553f6d3e48bf35,0xbf7fbf0e3ef13f80,0x3e953f7b3f22bec4
.quad 0xbf6dbf353ec43f80,0xbec43f353f6da554,0xbf46bf553e953f80,0xbf623e483f7f3ec4
.quad 0xbf0ebf6d3e483f80,0xbf7bbec43f553f35,0xbe95bf7b3dc93f80,0xbf22bf553ef13f6d
.quad 0xa554bf80248d3f80,0xa554bf80248d3f80,0x3e95bf7bbdc93f80,0x3f22bf55bef13f6d
.quad 0x3f0ebf6dbe483f80,0x3f7bbec4bf553f35,0x3f46bf55be953f80,0x3f623e48bf7f3ec4
.quad 0x3f6dbf35bec43f80,0x3ec43f35bf6d248d,0x3f7fbf0ebef13f80,0xbe953f7bbf22bec4
.quad 0x3f7bbec4bf0e3f80,0xbf553f6dbe48bf35,0x3f62be48bf223f80,0xbf7f3f0e3e95bf6d
.quad 0x3f35a554bf353f80,0xbf35248d3f35bf80,0x3ef13e48bf463f80,0xbdc9bf0e3f75bf6d
.quad 0x3e483ec4bf553f80,0x3f0ebf6d3f7bbf35,0xbdc93f0ebf623f80,0x3f75bf7b3f46bec4
.quad 0xbec43f35bf6d3f80,0x3f6dbf353ec4a554,0xbf223f55bf753f80,0x3ef1be48bdc93ec4
.quad 0xbf553f6dbf7b3f80,0xbe483ec4bf0e3f35,0xbf753f7bbf7f3f80,0xbf463f55bf623f6d
.quad 0x3f803f803f803f80,0x3f803f803f803f80,0x3ef13f0e3f223f35,0x3dc93e483e953ec4
.quad 0xbf0ebec4be48248d,0xbf7bbf6dbf55bf35,0xbf7fbf7bbf62bf35,0xbe95bf0ebf46bf6d
.quad 0xbec4bf35bf6dbf80,0x3f6d3f353ec4a554,0x3f223e48be95bf35,0x3ef13f553f7f3f6d
.quad 0x3f7b3f6d3f0ea554,0xbf55bec43e483f35,0x3e953f553f7f3f35,0xbf22bf7bbf62bec4
.quad 0xbf35248d3f353f80,0x3f35a554bf35bf80,0xbf75bf55bdc93f35,0x3f463f7b3ef1bec4
.quad 0xbe48bf6dbf55248d,0xbf0e3ec43f7b3f35,0x3f46be48bf75bf35,0xbf62bf553dc93f6d
.quad 0x3f6d3f35bec4bf80,0x3ec4bf35bf6d248d,0x3dc93f7b3ef1bf35,0x3f753f0ebf22bf6d
.quad 0xbf553ec43f7ba554,0xbe483f6d3f0ebf35,0xbf62bf0e3f463f35,0xbf7fbe483f753ec4
.quad 0xa554bf80248d3f80,0xa554bf80248d3f80,0x3f62bf0ebf463f35,0x3f7fbe48bf753ec4
.quad 0x3f553ec4bf7b248d,0x3e483f6dbf0ebf35,0xbdc93f7bbef1bf35,0xbf753f0e3f22bf6d
.quad 0xbf6d3f353ec4bf80,0xbec4bf353f6da554,0xbf46be483f75bf35,0x3f62bf55bdc93f6d
.quad 0x3e48bf6d3f55a554,0x3f0e3ec4bf7b3f35,0x3f75bf553dc93f35,0xbf463f7bbef1bec4
.quad 0x3f35a554bf353f80,0xbf35248d3f35bf80,0xbe953f55bf7f3f35,0x3f22bf7b3f62bec4
.quad 0xbf7b3f6dbf0e248d,0x3f55bec4be483f35,0xbf223e483e95bf35,0xbef13f55bf7f3f6d
.quad 0x3ec4bf353f6dbf80,0xbf6d3f35bec4248d,0x3f7fbf7b3f62bf35,0x3e95bf0e3f46bf6d
.quad 0x3f0ebec43e48a554,0x3f7bbf6d3f55bf35,0xbef13f0ebf223f35,0xbdc93e48be953ec4
.quad 0x3f803f803f803f80,0x3f803f803f803f80,0xbe95be48bdc9248d,0xbf22bf0ebef1bec4
.quad 0xbf55bf6dbf7bbf80,0xbe48bec4bf0ebf35,0x3f463f0e3e95a554,0x3f623f7b3f7f3f6d
.quad 0x3ec43f353f6d3f80,0xbf6dbf35bec4248d,0xbf7fbf55bef1248d,0x3e95be48bf22bf6d
.quad 0x3e48bec4bf55bf80,0x3f0e3f6d3f7b3f35,0x3f623f7b3f22a554,0xbf7fbf55be953ec4
.quad 0xbf35248d3f353f80,0x3f35a554bf35bf80,0xbef1bf7bbf46248d,0x3dc93f553f753ec4
.quad 0x3f7b3ec4bf0ebf80,0xbf55bf6dbe483f35,0xbdc93f553f62a554,0x3f753e48bf46bf6d
.quad 0xbf6dbf353ec43f80,0xbec43f353f6da554,0x3f22bf0ebf75248d,0xbef1bf7bbdc93f6d
.quad 0x3f0e3f6dbe48bf80,0x3f7b3ec4bf55bf35,0xbf753e483f7fa554,0xbf463f0e3f62bec4
.quad 0xa554bf80248d3f80,0xa554bf80248d3f80,0x3f753e48bf7f248d,0x3f463f0ebf62bec4
.quad 0xbf0e3f6d3e48bf80,0xbf7b3ec43f55bf35,0xbf22bf0e3f75a554,0x3ef1bf7b3dc93f6d
.quad 0x3f6dbf35bec43f80,0x3ec43f35bf6d248d,0x3dc93f55bf62248d,0xbf753e483f46bf6d
.quad 0xbf7b3ec43f0ebf80,0x3f55bf6d3e483f35,0x3ef1bf7b3f46a554,0xbdc93f55bf753ec4
.quad 0x3f35a554bf353f80,0xbf35248d3f35bf80,0xbf623f7bbf22248d,0x3f7fbf553e953ec4
.quad 0xbe48bec43f55bf80,0xbf0e3f6dbf7b3f35,0x3f7fbf553ef1a554,0xbe95be483f22bf6d
.quad 0xbec43f35bf6d3f80,0x3f6dbf353ec4a554,0xbf463f0ebe95248d,0xbf623f7bbf7f3f6d
.quad 0x3f55bf6d3f7bbf80,0x3e48bec43f0ebf35,0x3e95be483dc9a554,0x3f22bf0e3ef1bec4
.quad 0x3f803f803f803f80,0x3f803f803f803f80,0xbf62bf55bf46bf35,0xbf7fbf7bbf75bf6d
.quad 0x3f0e3ec43e48a554,0x3f7b3f6d3f553f35,0xbdc93e483ef13f35,0xbf75bf55bf22bec4
.quad 0xbec4bf35bf6dbf80,0x3f6d3f353ec4a554,0x3f463f7b3f753f35,0xbf62bf0ebdc93ec4
.quad 0xbf7bbf6dbf0e248d,0x3f553ec4be48bf35,0x3f753f0ebdc9bf35,0xbf46be483ef13f6d
.quad 0xbf35248d3f353f80,0x3f35a554bf35bf80,0x3e95bf0ebf7fbf35,0xbf223e483f623f6d
.quad 0x3e483f6d3f55a554,0x3f0ebec4bf7bbf35,0xbf22bf7bbe953f35,0xbef13f0e3f7f3ec4
.quad 0x3f6d3f35bec4bf80,0x3ec4bf35bf6d248d,0xbf7fbe483f623f35,0xbe953f553f46bec4
.quad 0x3f55bec4bf7b248d,0x3e48bf6dbf0e3f35,0xbef13f553f22bf35,0xbdc93f7b3e95bf6d
.quad 0xa554bf80248d3f80,0xa554bf80248d3f80,0x3ef13f55bf22bf35,0x3dc93f7bbe95bf6d
.quad 0xbf55bec43f7ba554,0xbe48bf6d3f0e3f35,0x3f7fbe48bf623f35,0x3e953f55bf46bec4
.quad 0xbf6d3f353ec4bf80,0xbec4bf353f6da554,0x3f22bf7b3e953f35,0x3ef13f0ebf7f3ec4
.quad 0xbe483f6dbf55248d,0xbf0ebec43f7bbf35,0xbe95bf0e3f7fbf35,0x3f223e48bf623f6d
.quad 0x3f35a554bf353f80,0xbf35248d3f35bf80,0xbf753f0e3dc9bf35,0x3f46be48bef13f6d
.quad 0x3f7bbf6d3f0ea554,0xbf553ec43e48bf35,0xbf463f7bbf753f35,0x3f62bf0e3dc93ec4
.quad 0x3ec4bf353f6dbf80,0xbf6d3f35bec4248d,0x3dc93e48bef13f35,0x3f75bf553f22bec4
.quad 0xbf0e3ec4be48248d,0xbf7b3f6dbf553f35,0x3f62bf553f46bf35,0x3f7fbf7b3f75bf6d
.quad 0x3f803f803f803f80,0x3f803f803f803f80,0xbf75bf7bbf7fbf80,0xbf46bf55bf62bf6d
.quad 0x3f553f6d3f7b3f80,0x3e483ec43f0e3f35,0xbf22bf55bf75bf80,0x3ef13e48bdc9bec4
.quad 0x3ec43f353f6d3f80,0xbf6dbf35bec4248d,0xbdc9bf0ebf62bf80,0x3f753f7b3f463ec4
.quad 0xbe483ec43f553f80,0xbf0ebf6dbf7bbf35,0x3ef1be48bf46bf80,0xbdc93f0e3f753f6d
.quad 0xbf35248d3f353f80,0x3f35a554bf35bf80,0x3f623e48bf22bf80,0xbf7fbf0e3e953f6d
.quad 0xbf7bbec43f0e3f80,0x3f553f6d3e48bf35,0x3f7f3f0ebef1bf80,0xbe95bf7bbf223ec4
.quad 0xbf6dbf353ec43f80,0xbec43f353f6da554,0x3f463f55be95bf80,0x3f62be48bf7fbec4
.quad 0xbf0ebf6d3e483f80,0xbf7bbec43f553f35,0x3e953f7bbdc9bf80,0x3f223f55bef1bf6d
.quad 0xa554bf80248d3f80,0xa554bf80248d3f80,0xbe953f7b3dc9bf80,0xbf223f553ef1bf6d
.quad 0x3f0ebf6dbe483f80,0x3f7bbec4bf553f35,0xbf463f553e95bf80,0xbf62be483f7fbec4
.quad 0x3f6dbf35bec43f80,0x3ec43f35bf6d248d,0xbf7f3f0e3ef1bf80,0x3e95bf7b3f223ec4
.quad 0x3f7bbec4bf0e3f80,0xbf553f6dbe48bf35,0xbf623e483f22bf80,0x3f7fbf0ebe953f6d
.quad 0x3f35a554bf353f80,0xbf35248d3f35bf80,0xbef1be483f46bf80,0x3dc93f0ebf753f6d
.quad 0x3e483ec4bf553f80,0x3f0ebf6d3f7bbf35,0x3dc9bf0e3f62bf80,0xbf753f7bbf463ec4
.quad 0xbec43f35bf6d3f80,0x3f6dbf353ec4a554,0x3f22bf553f75bf80,0xbef13e483dc9bec4
.quad 0xbf553f6dbf7b3f80,0xbe483ec4bf0e3f35,0x3f75bf7b3f7fbf80,0x3f46bf553f62bf6d
.quad 0x3f803f803f803f80,0x3f803f803f803f80,0xbef1bf0ebf22bf35,0xbdc9be48be95bec4
.quad 0xbf0ebec4be48248d,0xbf7bbf6dbf55bf35,0x3f7f3f7b3f623f35,0x3e953f0e3f463f6d
.quad 0xbec4bf35bf6dbf80,0x3f6d3f353ec4a554,0xbf22be483e953f35,0xbef1bf55bf7fbf6d
.quad 0x3f7b3f6d3f0ea554,0xbf55bec43e483f35,0xbe95bf55bf7fbf35,0x3f223f7b3f623ec4
.quad 0xbf35248d3f353f80,0x3f35a554bf35bf80,0x3f753f553dc9bf35,0xbf46bf7bbef13ec4
.quad 0xbe48bf6dbf55248d,0xbf0e3ec43f7b3f35,0xbf463e483f753f35,0x3f623f55bdc9bf6d
.quad 0x3f6d3f35bec4bf80,0x3ec4bf35bf6d248d,0xbdc9bf7bbef13f35,0xbf75bf0e3f223f6d
.quad 0xbf553ec43f7ba554,0xbe483f6d3f0ebf35,0x3f623f0ebf46bf35,0x3f7f3e48bf75bec4
.quad 0xa554bf80248d3f80,0xa554bf80248d3f80,0xbf623f0e3f46bf35,0xbf7f3e483f75bec4
.quad 0x3f553ec4bf7b248d,0x3e483f6dbf0ebf35,0x3dc9bf7b3ef13f35,0x3f75bf0ebf223f6d
.quad 0xbf6d3f353ec4bf80,0xbec4bf353f6da554,0x3f463e48bf753f35,0xbf623f553dc9bf6d
.quad 0x3e48bf6d3f55a554,0x3f0e3ec4bf7b3f35,0xbf753f55bdc9bf35,0x3f46bf7b3ef13ec4
.quad 0x3f35a554bf353f80,0xbf35248d3f35bf80,0x3e95bf553f7fbf35,0xbf223f7bbf623ec4
.quad 0xbf7b3f6dbf0e248d,0x3f55bec4be483f35,0x3f22be48be953f35,0x3ef1bf553f7fbf6d
.quad 0x3ec4bf353f6dbf80,0xbf6d3f35bec4248d,0xbf7f3f7bbf623f35,0xbe953f0ebf463f6d
.quad 0x3f0ebec43e48a554,0x3f7bbf6d3f55bf35,0x3ef1bf0e3f22bf35,0x3dc9be483e95bec4
.quad 0x3f803f803f803f80,0x3f803f803f803f80,0x3e953e483dc9a554,0x3f223f0e3ef13ec4
.quad 0xbf55bf6dbf7bbf80,0xbe48bec4bf0ebf35,0xbf46bf0ebe95248d,0xbf62bf7bbf7fbf6d
.quad 0x3ec43f353f6d3f80,0xbf6dbf35bec4248d,0x3f7f3f553ef1a554,0xbe953e483f223f6d
.quad 0x3e48bec4bf55bf80,0x3f0e3f6d3f7b3f35,0xbf62bf7bbf22248d,0x3f7f3f553e95bec4
.quad 0xbf35248d3f353f80,0x3f35a554bf35bf80,0x3ef13f7b3f46a554,0xbdc9bf55bf75bec4
.quad 0x3f7b3ec4bf0ebf80,0xbf55bf6dbe483f35,0x3dc9bf55bf62248d,0xbf75be483f463f6d
.quad 0xbf6dbf353ec43f80,0xbec43f353f6da554,0xbf223f0e3f75a554,0x3ef13f7b3dc9bf6d
.quad 0x3f0e3f6dbe48bf80,0x3f7b3ec4bf55bf35,0x3f75be48bf7f248d,0x3f46bf0ebf623ec4
.quad 0xa554bf80248d3f80,0xa554bf80248d3f80,0xbf75be483f7fa554,0xbf46bf0e3f623ec4
.quad 0xbf0e3f6d3e48bf80,0xbf7b3ec43f55bf35,0x3f223f0ebf75248d,0xbef13f7bbdc9bf6d
.quad 0x3f6dbf35bec43f80,0x3ec43f35bf6d248d,0xbdc9bf553f62a554,0x3f75be48bf463f6d
.quad 0xbf7b3ec43f0ebf80,0x3f55bf6d3e483f35,0xbef13f7bbf46248d,0x3dc9bf553f75bec4
.quad 0x3f35a554bf353f80,0xbf35248d3f35bf80,0x3f62bf7b3f22a554,0xbf7f3f55be95bec4
.quad 0xbe48bec43f55bf80,0xbf0e3f6dbf7b3f35,0xbf7f3f55bef1248d,0x3e953e48bf223f6d
.quad 0xbec43f35bf6d3f80,0x3f6dbf353ec4a554,0x3f46bf0e3e95a554,0x3f62bf7b3f7fbf6d
.quad 0x3f55bf6d3f7bbf80,0x3e48bec43f0ebf35,0xbe953e48bdc9248d,0xbf223f0ebef13ec4
.quad 0x3f803f803f803f80,0x3f803f803f803f80,0x3f623f553f463f35,0x3f7f3f7b3f753f6d
.quad 0x3f0e3ec43e48a554,0x3f7b3f6d3f553f35,0x3dc9be48bef1bf35,0x3f753f553f223ec4
.quad 0xbec4bf35bf6dbf80,0x3f6d3f353ec4a554,0xbf46bf7bbf75bf35,0x3f623f0e3dc9bec4
.quad 0xbf7bbf6dbf0e248d,0x3f553ec4be48bf35,0xbf75bf0e3dc93f35,0x3f463e48bef1bf6d
.quad 0xbf35248d3f353f80,0x3f35a554bf35bf80,0xbe953f0e3f7f3f35,0x3f22be48bf62bf6d
.quad 0x3e483f6d3f55a554,0x3f0ebec4bf7bbf35,0x3f223f7b3e95bf35,0x3ef1bf0ebf7fbec4
.quad 0x3f6d3f35bec4bf80,0x3ec4bf35bf6d248d,0x3f7f3e48bf62bf35,0x3e95bf55bf463ec4
.quad 0x3f55bec4bf7b248d,0x3e48bf6dbf0e3f35,0x3ef1bf55bf223f35,0x3dc9bf7bbe953f6d
.quad 0xa554bf80248d3f80,0xa554bf80248d3f80,0xbef1bf553f223f35,0xbdc9bf7b3e953f6d
.quad 0xbf55bec43f7ba554,0xbe48bf6d3f0e3f35,0xbf7f3e483f62bf35,0xbe95bf553f463ec4
.quad 0xbf6d3f353ec4bf80,0xbec4bf353f6da554,0xbf223f7bbe95bf35,0xbef1bf0e3f7fbec4
.quad 0xbe483f6dbf55248d,0xbf0ebec43f7bbf35,0x3e953f0ebf7f3f35,0xbf22be483f62bf6d
.quad 0x3f35a554bf353f80,0xbf35248d3f35bf80,0x3f75bf0ebdc93f35,0xbf463e483ef1bf6d
.quad 0x3f7bbf6d3f0ea554,0xbf553ec43e48bf35,0x3f46bf7b3f75bf35,0xbf623f0ebdc9bec4
.quad 0x3ec4bf353f6dbf80,0xbf6d3f35bec4248d,0xbdc9be483ef1bf35,0xbf753f55bf223ec4
.quad 0xbf0e3ec4be48248d,0xbf7b3f6dbf553f35,0xbf623f55bf463f35,0xbf7f3f7bbf753f6d
.quad 0x8000800080008000,0x8000800080008000,0xbe95be48bdc98000,0xbf22bf0ebef1bec4
.quad 0xbf0ebec4be488000,0xbf7bbf6dbf55bf35,0xbf46bf0ebe958000,0xbf62bf7bbf7fbf6d
.quad 0xbf6dbf35bec48000,0xbec4bf35bf6dbf80,0xbf7fbf55bef18000,0x3e95be48bf22bf6d
.quad 0xbf7bbf6dbf0e8000,0x3f553ec4be48bf35,0xbf62bf7bbf228000,0x3f7f3f553e95bec4
.quad 0xbf35bf80bf358000,0x3f353f803f35a50d,0xbef1bf7bbf468000,0x3dc93f553f753ec4
.quad 0xbe48bf6dbf558000,0xbf0e3ec43f7b3f35,0x3dc9bf55bf628000,0xbf75be483f463f6d
.quad 0x3ec4bf35bf6d8000,0xbf6dbf353ec43f80,0x3f22bf0ebf758000,0xbef1bf7bbdc93f6d
.quad 0x3f55bec4bf7b8000,0x3e48bf6dbf0e3f35,0x3f75be48bf7f8000,0x3f46bf0ebf623ec4
.quad 0x3f80a50dbf808000,0x3f80a50dbf808000,0x3f753e48bf7f8000,0x3f463f0ebf62bec4
.quad 0x3f553ec4bf7b8000,0x3e483f6dbf0ebf35,0x3f223f0ebf758000,0xbef13f7bbdc9bf6d
.quad 0x3ec43f35bf6d8000,0xbf6d3f353ec4bf80,0x3dc93f55bf628000,0xbf753e483f46bf6d
.quad 0xbe483f6dbf558000,0xbf0ebec43f7bbf35,0xbef13f7bbf468000,0x3dc9bf553f75bec4
.quad 0xbf353f80bf358000,0x3f35bf803f35a50d,0xbf623f7bbf228000,0x3f7fbf553e953ec4
.quad 0xbf7b3f6dbf0e8000,0x3f55bec4be483f35,0xbf7f3f55bef18000,0x3e953e48bf223f6d
.quad 0xbf6d3f35bec48000,0xbec43f35bf6d3f80,0xbf463f0ebe958000,0xbf623f7bbf7f3f6d
.quad 0xbf0e3ec4be488000,0xbf7b3f6dbf553f35,0xbe953e48bdc98000,0xbf223f0ebef13ec4
.quad 0x8000800080008000,0x8000800080008000,0xbf62bf55bf46bf35,0xbf7fbf7bbf75bf6d
.quad 0xbf55bf6dbf7bbf80,0xbe48bec4bf0ebf35,0x3dc9be48bef1bf35,0x3f753f553f223ec4
.quad 0x3f6d3f353ec4a50d,0x3ec43f353f6d3f80,0x3f463f7b3f753f35,0xbf62bf0ebdc93ec4
.quad 0xbe483ec43f553f80,0xbf0ebf6dbf7bbf35,0xbf75bf0e3dc93f35,0x3f463e48bef1bf6d
.quad 0xbf35bf80bf358000,0x3f353f803f35a50d,0x3e95bf0ebf7fbf35,0xbf223e483f623f6d
.quad 0x3f7b3ec4bf0ebf80,0xbf55bf6dbe483f35,0x3f223f7b3e95bf35,0x3ef1bf0ebf7fbec4
.quad 0xbec43f353f6da50d,0x3f6d3f35bec4bf80,0xbf7fbe483f623f35,0xbe953f553f46bec4
.quad 0xbf0ebf6d3e483f80,0xbf7bbec43f553f35,0x3ef1bf55bf223f35,0x3dc9bf7bbe953f6d
.quad 0x3f80a50dbf808000,0x3f80a50dbf808000,0x3ef13f55bf22bf35,0x3dc93f7bbe95bf6d
.quad 0xbf0e3f6d3e48bf80,0xbf7b3ec43f55bf35,0xbf7f3e483f62bf35,0xbe95bf553f463ec4
.quad 0xbec4bf353f6da50d,0x3f6dbf35bec43f80,0x3f22bf7b3e953f35,0x3ef13f0ebf7f3ec4
.quad 0x3f7bbec4bf0e3f80,0xbf553f6dbe48bf35,0x3e953f0ebf7f3f35,0xbf22be483f62bf6d
.quad 0xbf353f80bf358000,0x3f35bf803f35a50d,0xbf753f0e3dc9bf35,0x3f46be48bef13f6d
.quad 0xbe48bec43f55bf80,0xbf0e3f6dbf7b3f35,0x3f46bf7b3f75bf35,0xbf623f0ebdc9bec4
.quad 0x3f6dbf353ec4a50d,0x3ec4bf353f6dbf80,0x3dc93e48bef13f35,0x3f75bf553f22bec4
.quad 0xbf553f6dbf7b3f80,0xbe483ec4bf0e3f35,0xbf623f55bf463f35,0xbf7f3f7bbf753f6d
.quad 0x8000800080008000,0x8000800080008000,0xbf75bf7bbf7fbf80,0xbf46bf55bf62bf6d
.quad 0x3f0e3ec43e48a50d,0x3f7b3f6d3f553f35,0x3f223f553f753f80,0xbef1be483dc93ec4
.quad 0xbf6dbf35bec48000,0xbec4bf35bf6dbf80,0xbdc9bf0ebf62bf80,0x3f753f7b3f463ec4
.quad 0x3f7b3f6d3f0ea50d,0xbf55bec43e483f35,0xbef13e483f463f80,0x3dc9bf0ebf75bf6d
.quad 0xbf35bf80bf358000,0x3f353f803f35a50d,0x3f623e48bf22bf80,0xbf7fbf0e3e953f6d
.quad 0x3e483f6d3f55a50d,0x3f0ebec4bf7bbf35,0xbf7fbf0e3ef13f80,0x3e953f7b3f22bec4
.quad 0x3ec4bf35bf6d8000,0xbf6dbf353ec43f80,0x3f463f55be95bf80,0x3f62be48bf7fbec4
.quad 0xbf553ec43f7ba50d,0xbe483f6d3f0ebf35,0xbe95bf7b3dc93f80,0xbf22bf553ef13f6d
.quad 0x3f80a50dbf808000,0x3f80a50dbf808000,0xbe953f7b3dc9bf80,0xbf223f553ef1bf6d
.quad 0xbf55bec43f7ba50d,0xbe48bf6d3f0e3f35,0x3f46bf55be953f80,0x3f623e48bf7f3ec4
.quad 0x3ec43f35bf6d8000,0xbf6d3f353ec4bf80,0xbf7f3f0e3ef1bf80,0x3e95bf7b3f223ec4
.quad 0x3e48bf6d3f55a50d,0x3f0e3ec4bf7b3f35,0x3f62be48bf223f80,0xbf7f3f0e3e95bf6d
.quad 0xbf353f80bf358000,0x3f35bf803f35a50d,0xbef1be483f46bf80,0x3dc93f0ebf753f6d
.quad 0x3f7bbf6d3f0ea50d,0xbf553ec43e48bf35,0xbdc93f0ebf623f80,0x3f75bf7b3f46bec4
.quad 0xbf6d3f35bec48000,0xbec43f35bf6d3f80,0x3f22bf553f75bf80,0xbef13e483dc9bec4
.quad 0x3f0ebec43e48a50d,0x3f7bbf6d3f55bf35,0xbf753f7bbf7f3f80,0xbf463f55bf623f6d
.quad 0x8000800080008000,0x8000800080008000,0xbef1bf0ebf22bf35,0xbdc9be48be95bec4
.quad 0x3f553f6d3f7b3f80,0x3e483ec43f0e3f35,0xbf7fbf7bbf62bf35,0xbe95bf0ebf46bf6d
.quad 0x3f6d3f353ec4a50d,0x3ec43f353f6d3f80,0xbf22be483e953f35,0xbef1bf55bf7fbf6d
.quad 0x3e48bec4bf55bf80,0x3f0e3f6d3f7b3f35,0x3e953f553f7f3f35,0xbf22bf7bbf62bec4
.quad 0xbf35bf80bf358000,0x3f353f803f35a50d,0x3f753f553dc9bf35,0xbf46bf7bbef13ec4
.quad 0xbf7bbec43f0e3f80,0x3f553f6d3e48bf35,0x3f46be48bf75bf35,0xbf62bf553dc93f6d
.quad 0xbec43f353f6da50d,0x3f6d3f35bec4bf80,0xbdc9bf7bbef13f35,0xbf75bf0e3f223f6d
.quad 0x3f0e3f6dbe48bf80,0x3f7b3ec4bf55bf35,0xbf62bf0e3f463f35,0xbf7fbe483f753ec4
.quad 0x3f80a50dbf808000,0x3f80a50dbf808000,0xbf623f0e3f46bf35,0xbf7f3e483f75bec4
.quad 0x3f0ebf6dbe483f80,0x3f7bbec4bf553f35,0xbdc93f7bbef1bf35,0xbf753f0e3f22bf6d
.quad 0xbec4bf353f6da50d,0x3f6dbf35bec43f80,0x3f463e48bf753f35,0xbf623f553dc9bf6d
.quad 0xbf7b3ec43f0ebf80,0x3f55bf6d3e483f35,0x3f75bf553dc93f35,0xbf463f7bbef1bec4
.quad 0xbf353f80bf358000,0x3f35bf803f35a50d,0x3e95bf553f7fbf35,0xbf223f7bbf623ec4
.quad 0x3e483ec4bf553f80,0x3f0ebf6d3f7bbf35,0xbf223e483e95bf35,0xbef13f55bf7f3f6d
.quad 0x3f6dbf353ec4a50d,0x3ec4bf353f6dbf80,0xbf7f3f7bbf623f35,0xbe953f0ebf463f6d
.quad 0x3f55bf6d3f7bbf80,0x3e48bec43f0ebf35,0xbef13f0ebf223f35,0xbdc93e48be953ec4
.quad 0x8000800080008000,0x8000800080008000,0x3e953e483dc9a50d,0x3f223f0e3ef13ec4
.quad 0xbf0ebec4be488000,0xbf7bbf6dbf55bf35,0x3f463f0e3e95a50d,0x3f623f7b3f7f3f6d
.quad 0xbf6dbf35bec48000,0xbec4bf35bf6dbf80,0x3f7f3f553ef1a50d,0xbe953e483f223f6d
.quad 0xbf7bbf6dbf0e8000,0x3f553ec4be48bf35,0x3f623f7b3f22a50d,0xbf7fbf55be953ec4
.quad 0xbf35bf80bf358000,0x3f353f803f35a50d,0x3ef13f7b3f46a50d,0xbdc9bf55bf75bec4
.quad 0xbe48bf6dbf558000,0xbf0e3ec43f7b3f35,0xbdc93f553f62a50d,0x3f753e48bf46bf6d
.quad 0x3ec4bf35bf6d8000,0xbf6dbf353ec43f80,0xbf223f0e3f75a50d,0x3ef13f7b3dc9bf6d
.quad 0x3f55bec4bf7b8000,0x3e48bf6dbf0e3f35,0xbf753e483f7fa50d,0xbf463f0e3f62bec4
.quad 0x3f80a50dbf808000,0x3f80a50dbf808000,0xbf75be483f7fa50d,0xbf46bf0e3f623ec4
.quad 0x3f553ec4bf7b8000,0x3e483f6dbf0ebf35,0xbf22bf0e3f75a50d,0x3ef1bf7b3dc93f6d
.quad 0x3ec43f35bf6d8000,0xbf6d3f353ec4bf80,0xbdc9bf553f62a50d,0x3f75be48bf463f6d
.quad 0xbe483f6dbf558000,0xbf0ebec43f7bbf35,0x3ef1bf7b3f46a50d,0xbdc93f55bf753ec4
.quad 0xbf353f80bf358000,0x3f35bf803f35a50d,0x3f62bf7b3f22a50d,0xbf7f3f55be95bec4
.quad 0xbf7b3f6dbf0e8000,0x3f55bec4be483f35,0x3f7fbf553ef1a50d,0xbe95be483f22bf6d
.quad 0xbf6d3f35bec48000,0xbec43f35bf6d3f80,0x3f46bf0e3e95a50d,0x3f62bf7b3f7fbf6d
.quad 0xbf0e3ec4be488000,0xbf7b3f6dbf553f35,0x3e95be483dc9a50d,0x3f22bf0e3ef1bec4
.quad 0x8000800080008000,0x8000800080008000,0x3f623f553f463f35,0x3f7f3f7b3f753f6d
.quad 0xbf55bf6dbf7bbf80,0xbe48bec4bf0ebf35,0xbdc93e483ef13f35,0xbf75bf55bf22bec4
.quad 0x3f6d3f353ec4a50d,0x3ec43f353f6d3f80,0xbf46bf7bbf75bf35,0x3f623f0e3dc9bec4
.quad 0xbe483ec43f553f80,0xbf0ebf6dbf7bbf35,0x3f753f0ebdc9bf35,0xbf46be483ef13f6d
.quad 0xbf35bf80bf358000,0x3f353f803f35a50d,0xbe953f0e3f7f3f35,0x3f22be48bf62bf6d
.quad 0x3f7b3ec4bf0ebf80,0xbf55bf6dbe483f35,0xbf22bf7bbe953f35,0xbef13f0e3f7f3ec4
.quad 0xbec43f353f6da50d,0x3f6d3f35bec4bf80,0x3f7f3e48bf62bf35,0x3e95bf55bf463ec4
.quad 0xbf0ebf6d3e483f80,0xbf7bbec43f553f35,0xbef13f553f22bf35,0xbdc93f7b3e95bf6d
.quad 0x3f80a50dbf808000,0x3f80a50dbf808000,0xbef1bf553f223f35,0xbdc9bf7b3e953f6d
.quad 0xbf0e3f6d3e48bf80,0xbf7b3ec43f55bf35,0x3f7fbe48bf623f35,0x3e953f55bf46bec4
.quad 0xbec4bf353f6da50d,0x3f6dbf35bec43f80,0xbf223f7bbe95bf35,0xbef1bf0e3f7fbec4
.quad 0x3f7bbec4bf0e3f80,0xbf553f6dbe48bf35,0xbe95bf0e3f7fbf35,0x3f223e48bf623f6d
.quad 0xbf353f80bf358000,0x3f35bf803f35a50d,0x3f75bf0ebdc93f35,0xbf463e483ef1bf6d
.quad 0xbe48bec43f55bf80,0xbf0e3f6dbf7b3f35,0xbf463f7bbf753f35,0x3f62bf0e3dc93ec4
.quad 0x3f6dbf353ec4a50d,0x3ec4bf353f6dbf80,0xbdc9be483ef1bf35,0xbf753f55bf223ec4
.quad 0xbf553f6dbf7b3f80,0xbe483ec4bf0e3f35,0x3f62bf553f46bf35,0x3f7fbf7b3f75bf6d
.quad 0x8000800080008000,0x8000800080008000,0x3f753f7b3f7f3f80,0x3f463f553f623f6d
.quad 0x3f0e3ec43e48a50d,0x3f7b3f6d3f553f35,0xbf22bf55bf75bf80,0x3ef13e48bdc9bec4
.quad 0xbf6dbf35bec48000,0xbec4bf35bf6dbf80,0x3dc93f0e3f623f80,0xbf75bf7bbf46bec4
.quad 0x3f7b3f6d3f0ea50d,0xbf55bec43e483f35,0x3ef1be48bf46bf80,0xbdc93f0e3f753f6d
.quad 0xbf35bf80bf358000,0x3f353f803f35a50d,0xbf62be483f223f80,0x3f7f3f0ebe95bf6d
.quad 0x3e483f6d3f55a50d,0x3f0ebec4bf7bbf35,0x3f7f3f0ebef1bf80,0xbe95bf7bbf223ec4
.quad 0x3ec4bf35bf6d8000,0xbf6dbf353ec43f80,0xbf46bf553e953f80,0xbf623e483f7f3ec4
.quad 0xbf553ec43f7ba50d,0xbe483f6d3f0ebf35,0x3e953f7bbdc9bf80,0x3f223f55bef1bf6d
.quad 0x3f80a50dbf808000,0x3f80a50dbf808000,0x3e95bf7bbdc93f80,0x3f22bf55bef13f6d
.quad 0xbf55bec43f7ba50d,0xbe48bf6d3f0e3f35,0xbf463f553e95bf80,0xbf62be483f7fbec4
.quad 0x3ec43f35bf6d8000,0xbf6d3f353ec4bf80,0x3f7fbf0ebef13f80,0xbe953f7bbf22bec4
.quad 0x3e48bf6d3f55a50d,0x3f0e3ec4bf7b3f35,0xbf623e483f22bf80,0x3f7fbf0ebe953f6d
.quad 0xbf353f80bf358000,0x3f35bf803f35a50d,0x3ef13e48bf463f80,0xbdc9bf0e3f75bf6d
.quad 0x3f7bbf6d3f0ea50d,0xbf553ec43e48bf35,0x3dc9bf0e3f62bf80,0xbf753f7bbf463ec4
.quad 0xbf6d3f35bec48000,0xbec43f35bf6d3f80,0xbf223f55bf753f80,0x3ef1be48bdc93ec4
.quad 0x3f0ebec43e48a50d,0x3f7bbf6d3f55bf35,0x3f75bf7b3f7fbf80,0x3f46bf553f62bf6d
.quad 0x8000800080008000,0x8000800080008000,0x3ef13f0e3f223f35,0x3dc93e483e953ec4
.quad 0x3f553f6d3f7b3f80,0x3e483ec43f0e3f35,0x3f7f3f7b3f623f35,0x3e953f0e3f463f6d
.quad 0x3f6d3f353ec4a50d,0x3ec43f353f6d3f80,0x3f223e48be95bf35,0x3ef13f553f7f3f6d
.quad 0x3e48bec4bf55bf80,0x3f0e3f6d3f7b3f35,0xbe95bf55bf7fbf35,0x3f223f7b3f623ec4
.quad 0xbf35bf80bf358000,0x3f353f803f35a50d,0xbf75bf55bdc93f35,0x3f463f7b3ef1bec4
.quad 0xbf7bbec43f0e3f80,0x3f553f6d3e48bf35,0xbf463e483f753f35,0x3f623f55bdc9bf6d
.quad 0xbec43f353f6da50d,0x3f6d3f35bec4bf80,0x3dc93f7b3ef1bf35,0x3f753f0ebf22bf6d
.quad 0x3f0e3f6dbe48bf80,0x3f7b3ec4bf55bf35,0x3f623f0ebf46bf35,0x3f7f3e48bf75bec4
.quad 0x3f80a50dbf808000,0x3f80a50dbf808000,0x3f62bf0ebf463f35,0x3f7fbe48bf753ec4
.quad 0x3f0ebf6dbe483f80,0x3f7bbec4bf553f35,0x3dc9bf7b3ef13f35,0x3f75bf0ebf223f6d
.quad 0xbec4bf353f6da50d,0x3f6dbf35bec43f80,0xbf46be483f75bf35,0x3f62bf55bdc93f6d
.quad 0xbf7b3ec43f0ebf80,0x3f55bf6d3e483f35,0xbf753f55bdc9bf35,0x3f46bf7b3ef13ec4
.quad 0xbf353f80bf358000,0x3f35bf803f35a50d,0xbe953f55bf7f3f35,0x3f22bf7b3f62bec4
.quad 0x3e483ec4bf553f80,0x3f0ebf6d3f7bbf35,0x3f22be48be953f35,0x3ef1bf553f7fbf6d
.quad 0x3f6dbf353ec4a50d,0x3ec4bf353f6dbf80,0x3f7fbf7b3f62bf35,0x3e95bf0e3f46bf6d
.quad 0x3f55bf6d3f7bbf80,0x3e48bec43f0ebf35,0x3ef1bf0e3f22bf35,0x3dc9be483e95bec4
.quad 0xbf803f80bf803f80,0xbf803f80bf803f80,0xbf753f7bbf7f3f80,0xbf463f55bf623f6d
.quad 0xbf553f6dbf7b3f80,0xbe483ec4bf0e3f35,0xbf223f55bf753f80,0x3ef1be48bdc93ec4
.quad 0xbec43f35bf6d3f80,0x3f6dbf353ec4248d,0xbdc93f0ebf623f80,0x3f75bf7b3f46bec4
.quad 0x3e483ec4bf553f80,0x3f0ebf6d3f7bbf35,0x3ef13e48bf463f80,0xbdc9bf0e3f75bf6d
.quad 0x3f35248dbf353f80,0xbf35a5543f35bf80,0x3f62be48bf223f80,0xbf7f3f0e3e95bf6d
.quad 0x3f7bbec4bf0e3f80,0xbf553f6dbe48bf35,0x3f7fbf0ebef13f80,0xbe953f7bbf22bec4
.quad 0x3f6dbf35bec43f80,0x3ec43f35bf6da554,0x3f46bf55be953f80,0x3f623e48bf7f3ec4
.quad 0x3f0ebf6dbe483f80,0x3f7bbec4bf553f35,0x3e95bf7bbdc93f80,0x3f22bf55bef13f6d
.quad 0x248dbf80a5543f80,0x248dbf80a5543f80,0xbe95bf7b3dc93f80,0xbf22bf553ef13f6d
.quad 0xbf0ebf6d3e483f80,0xbf7bbec43f553f35,0xbf46bf553e953f80,0xbf623e483f7f3ec4
.quad 0xbf6dbf353ec43f80,0xbec43f353f6d248d,0xbf7fbf0e3ef13f80,0x3e953f7b3f22bec4
.quad 0xbf7bbec43f0e3f80,0x3f553f6d3e48bf35,0xbf62be483f223f80,0x3f7f3f0ebe95bf6d
.quad 0xbf35a5543f353f80,0x3f35248dbf35bf80,0xbef13e483f463f80,0x3dc9bf0ebf75bf6d
.quad 0xbe483ec43f553f80,0xbf0ebf6dbf7bbf35,0x3dc93f0e3f623f80,0xbf75bf7bbf46bec4
.quad 0x3ec43f353f6d3f80,0xbf6dbf35bec4a554,0x3f223f553f753f80,0xbef1be483dc93ec4
.quad 0x3f553f6d3f7b3f80,0x3e483ec43f0e3f35,0x3f753f7b3f7f3f80,0x3f463f553f623f6d
.quad 0xbf803f80bf803f80,0xbf803f80bf803f80,0xbef13f0ebf223f35,0xbdc93e48be953ec4
.quad 0x3f0ebec43e48248d,0x3f7bbf6d3f55bf35,0x3f7fbf7b3f62bf35,0x3e95bf0e3f46bf6d
.quad 0x3ec4bf353f6dbf80,0xbf6d3f35bec4a554,0xbf223e483e95bf35,0xbef13f55bf7f3f6d
.quad 0xbf7b3f6dbf0ea554,0x3f55bec4be483f35,0xbe953f55bf7f3f35,0x3f22bf7b3f62bec4
.quad 0x3f35248dbf353f80,0xbf35a5543f35bf80,0x3f75bf553dc93f35,0xbf463f7bbef1bec4
.quad 0x3e48bf6d3f55248d,0x3f0e3ec4bf7b3f35,0xbf46be483f75bf35,0x3f62bf55bdc93f6d
.quad 0xbf6d3f353ec4bf80,0xbec4bf353f6d248d,0xbdc93f7bbef1bf35,0xbf753f0e3f22bf6d
.quad 0x3f553ec4bf7ba554,0x3e483f6dbf0ebf35,0x3f62bf0ebf463f35,0x3f7fbe48bf753ec4
.quad 0x248dbf80a5543f80,0x248dbf80a5543f80,0xbf62bf0e3f463f35,0xbf7fbe483f753ec4
.quad 0xbf553ec43f7b248d,0xbe483f6d3f0ebf35,0x3dc93f7b3ef1bf35,0x3f753f0ebf22bf6d
.quad 0x3f6d3f35bec4bf80,0x3ec4bf35bf6da554,0x3f46be48bf75bf35,0xbf62bf553dc93f6d
.quad 0xbe48bf6dbf55a554,0xbf0e3ec43f7b3f35,0xbf75bf55bdc93f35,0x3f463f7b3ef1bec4
.quad 0xbf35a5543f353f80,0x3f35248dbf35bf80,0x3e953f553f7f3f35,0xbf22bf7bbf62bec4
.quad 0x3f7b3f6d3f0e248d,0xbf55bec43e483f35,0x3f223e48be95bf35,0x3ef13f553f7f3f6d
.quad 0xbec4bf35bf6dbf80,0x3f6d3f353ec4248d,0xbf7fbf7bbf62bf35,0xbe95bf0ebf46bf6d
.quad 0xbf0ebec4be48a554,0xbf7bbf6dbf55bf35,0x3ef13f0e3f223f35,0x3dc93e483e953ec4
.quad 0xbf803f80bf803f80,0xbf803f80bf803f80,0x3e95be483dc9248d,0x3f22bf0e3ef1bec4
.quad 0x3f55bf6d3f7bbf80,0x3e48bec43f0ebf35,0xbf463f0ebe95a554,0xbf623f7bbf7f3f6d
.quad 0xbec43f35bf6d3f80,0x3f6dbf353ec4248d,0x3f7fbf553ef1248d,0xbe95be483f22bf6d
.quad 0xbe48bec43f55bf80,0xbf0e3f6dbf7b3f35,0xbf623f7bbf22a554,0x3f7fbf553e953ec4
.quad 0x3f35248dbf353f80,0xbf35a5543f35bf80,0x3ef1bf7b3f46248d,0xbdc93f55bf753ec4
.quad 0xbf7b3ec43f0ebf80,0x3f55bf6d3e483f35,0x3dc93f55bf62a554,0xbf753e483f46bf6d
.quad 0x3f6dbf35bec43f80,0x3ec43f35bf6da554,0xbf22bf0e3f75248d,0x3ef1bf7b3dc93f6d
.quad 0xbf0e3f6d3e48bf80,0xbf7b3ec43f55bf35,0x3f753e48bf7fa554,0x3f463f0ebf62bec4
.quad 0x248dbf80a5543f80,0x248dbf80a5543f80,0xbf753e483f7f248d,0xbf463f0e3f62bec4
.quad 0x3f0e3f6dbe48bf80,0x3f7b3ec4bf55bf35,0x3f22bf0ebf75a554,0xbef1bf7bbdc93f6d
.quad 0xbf6dbf353ec43f80,0xbec43f353f6d248d,0xbdc93f553f62248d,0x3f753e48bf46bf6d
.quad 0x3f7b3ec4bf0ebf80,0xbf55bf6dbe483f35,0xbef1bf7bbf46a554,0x3dc93f553f753ec4
.quad 0xbf35a5543f353f80,0x3f35248dbf35bf80,0x3f623f7b3f22248d,0xbf7fbf55be953ec4
.quad 0x3e48bec4bf55bf80,0x3f0e3f6d3f7b3f35,0xbf7fbf55bef1a554,0x3e95be48bf22bf6d
.quad 0x3ec43f353f6d3f80,0xbf6dbf35bec4a554,0x3f463f0e3e95248d,0x3f623f7b3f7f3f6d
.quad 0xbf55bf6dbf7bbf80,0xbe48bec4bf0ebf35,0xbe95be48bdc9a554,0xbf22bf0ebef1bec4
.quad 0xbf803f80bf803f80,0xbf803f80bf803f80,0x3f62bf553f46bf35,0x3f7fbf7b3f75bf6d
.quad 0xbf0e3ec4be48a554,0xbf7b3f6dbf553f35,0x3dc93e48bef13f35,0x3f75bf553f22bec4
.quad 0x3ec4bf353f6dbf80,0xbf6d3f35bec4a554,0xbf463f7bbf753f35,0x3f62bf0e3dc93ec4
.quad 0x3f7bbf6d3f0e248d,0xbf553ec43e48bf35,0xbf753f0e3dc9bf35,0x3f46be48bef13f6d
.quad 0x3f35248dbf353f80,0xbf35a5543f35bf80,0xbe95bf0e3f7fbf35,0x3f223e48bf623f6d
.quad 0xbe483f6dbf55a554,0xbf0ebec43f7bbf35,0x3f22bf7b3e953f35,0x3ef13f0ebf7f3ec4
.quad 0xbf6d3f353ec4bf80,0xbec4bf353f6d248d,0x3f7fbe48bf623f35,0x3e953f55bf46bec4
.quad 0xbf55bec43f7b248d,0xbe48bf6d3f0e3f35,0x3ef13f55bf22bf35,0x3dc93f7bbe95bf6d
.quad 0x248dbf80a5543f80,0x248dbf80a5543f80,0xbef13f553f22bf35,0xbdc93f7b3e95bf6d
.quad 0x3f55bec4bf7ba554,0x3e48bf6dbf0e3f35,0xbf7fbe483f623f35,0xbe953f553f46bec4
.quad 0x3f6d3f35bec4bf80,0x3ec4bf35bf6da554,0xbf22bf7bbe953f35,0xbef13f0e3f7f3ec4
.quad 0x3e483f6d3f55248d,0x3f0ebec4bf7bbf35,0x3e95bf0ebf7fbf35,0xbf223e483f623f6d
.quad 0xbf35a5543f353f80,0x3f35248dbf35bf80,0x3f753f0ebdc9bf35,0xbf46be483ef13f6d
.quad 0xbf7bbf6dbf0ea554,0x3f553ec4be48bf35,0x3f463f7b3f753f35,0xbf62bf0ebdc93ec4
.quad 0xbec4bf35bf6dbf80,0x3f6d3f353ec4248d,0xbdc93e483ef13f35,0xbf75bf55bf22bec4
.quad 0x3f0e3ec43e48248d,0x3f7b3f6d3f553f35,0xbf62bf55bf46bf35,0xbf7fbf7bbf75bf6d
.quad 0xbf803f80bf803f80,0xbf803f80bf803f80,0x3f75bf7b3f7fbf80,0x3f46bf553f62bf6d
.quad 0xbf553f6dbf7b3f80,0xbe483ec4bf0e3f35,0x3f22bf553f75bf80,0xbef13e483dc9bec4
.quad 0xbec43f35bf6d3f80,0x3f6dbf353ec4248d,0x3dc9bf0e3f62bf80,0xbf753f7bbf463ec4
.quad 0x3e483ec4bf553f80,0x3f0ebf6d3f7bbf35,0xbef1be483f46bf80,0x3dc93f0ebf753f6d
.quad 0x3f35248dbf353f80,0xbf35a5543f35bf80,0xbf623e483f22bf80,0x3f7fbf0ebe953f6d
.quad 0x3f7bbec4bf0e3f80,0xbf553f6dbe48bf35,0xbf7f3f0e3ef1bf80,0x3e95bf7b3f223ec4
.quad 0x3f6dbf35bec43f80,0x3ec43f35bf6da554,0xbf463f553e95bf80,0xbf62be483f7fbec4
.quad 0x3f0ebf6dbe483f80,0x3f7bbec4bf553f35,0xbe953f7b3dc9bf80,0xbf223f553ef1bf6d
.quad 0x248dbf80a5543f80,0x248dbf80a5543f80,0x3e953f7bbdc9bf80,0x3f223f55bef1bf6d
.quad 0xbf0ebf6d3e483f80,0xbf7bbec43f553f35,0x3f463f55be95bf80,0x3f62be48bf7fbec4
.quad 0xbf6dbf353ec43f80,0xbec43f353f6d248d,0x3f7f3f0ebef1bf80,0xbe95bf7bbf223ec4
.quad 0xbf7bbec43f0e3f80,0x3f553f6d3e48bf35,0x3f623e48bf22bf80,0xbf7fbf0e3e953f6d
.quad 0xbf35a5543f353f80,0x3f35248dbf35bf80,0x3ef1be48bf46bf80,0xbdc93f0e3f753f6d
.quad 0xbe483ec43f553f80,0xbf0ebf6dbf7bbf35,0xbdc9bf0ebf62bf80,0x3f753f7b3f463ec4
.quad 0x3ec43f353f6d3f80,0xbf6dbf35bec4a554,0xbf22bf55bf75bf80,0x3ef13e48bdc9bec4
.quad 0x3f553f6d3f7b3f80,0x3e483ec43f0e3f35,0xbf75bf7bbf7fbf80,0xbf46bf55bf62bf6d
.quad 0xbf803f80bf803f80,0xbf803f80bf803f80,0x3ef1bf0e3f22bf35,0x3dc9be483e95bec4
.quad 0x3f0ebec43e48248d,0x3f7bbf6d3f55bf35,0xbf7f3f7bbf623f35,0xbe953f0ebf463f6d
.quad 0x3ec4bf353f6dbf80,0xbf6d3f35bec4a554,0x3f22be48be953f35,0x3ef1bf553f7fbf6d
.quad 0xbf7b3f6dbf0ea554,0x3f55bec4be483f35,0x3e95bf553f7fbf35,0xbf223f7bbf623ec4
.quad 0x3f35248dbf353f80,0xbf35a5543f35bf80,0xbf753f55bdc9bf35,0x3f46bf7b3ef13ec4
.quad 0x3e48bf6d3f55248d,0x3f0e3ec4bf7b3f35,0x3f463e48bf753f35,0xbf623f553dc9bf6d
.quad 0xbf6d3f353ec4bf80,0xbec4bf353f6d248d,0x3dc9bf7b3ef13f35,0x3f75bf0ebf223f6d
.quad 0x3f553ec4bf7ba554,0x3e483f6dbf0ebf35,0xbf623f0e3f46bf35,0xbf7f3e483f75bec4
.quad 0x248dbf80a5543f80,0x248dbf80a5543f80,0x3f623f0ebf46bf35,0x3f7f3e48bf75bec4
.quad 0xbf553ec43f7b248d,0xbe483f6d3f0ebf35,0xbdc9bf7bbef13f35,0xbf75bf0e3f223f6d
.quad 0x3f6d3f35bec4bf80,0x3ec4bf35bf6da554,0xbf463e483f753f35,0x3f623f55bdc9bf6d
.quad 0xbe48bf6dbf55a554,0xbf0e3ec43f7b3f35,0x3f753f553dc9bf35,0xbf46bf7bbef13ec4
.quad 0xbf35a5543f353f80,0x3f35248dbf35bf80,0xbe95bf55bf7fbf35,0x3f223f7b3f623ec4
.quad 0x3f7b3f6d3f0e248d,0xbf55bec43e483f35,0xbf22be483e953f35,0xbef1bf55bf7fbf6d
.quad 0xbec4bf35bf6dbf80,0x3f6d3f353ec4248d,0x3f7f3f7b3f623f35,0x3e953f0e3f463f6d
.quad 0xbf0ebec4be48a554,0xbf7bbf6dbf55bf35,0xbef1bf0ebf22bf35,0xbdc9be48be95bec4
.quad 0xbf803f80bf803f80,0xbf803f80bf803f80,0xbe953e48bdc9a554,0xbf223f0ebef13ec4
.quad 0x3f55bf6d3f7bbf80,0x3e48bec43f0ebf35,0x3f46bf0e3e95248d,0x3f62bf7b3f7fbf6d
.quad 0xbec43f35bf6d3f80,0x3f6dbf353ec4248d,0xbf7f3f55bef1a554,0x3e953e48bf223f6d
.quad 0xbe48bec43f55bf80,0xbf0e3f6dbf7b3f35,0x3f62bf7b3f22248d,0xbf7f3f55be95bec4
.quad 0x3f35248dbf353f80,0xbf35a5543f35bf80,0xbef13f7bbf46a554,0x3dc9bf553f75bec4
.quad 0xbf7b3ec43f0ebf80,0x3f55bf6d3e483f35,0xbdc9bf553f62248d,0x3f75be48bf463f6d
.quad 0x3f6dbf35bec43f80,0x3ec43f35bf6da554,0x3f223f0ebf75a554,0xbef13f7bbdc9bf6d
.quad 0xbf0e3f6d3e48bf80,0xbf7b3ec43f55bf35,0xbf75be483f7f248d,0xbf46bf0e3f623ec4
.quad 0x248dbf80a5543f80,0x248dbf80a5543f80,0x3f75be48bf7fa554,0x3f46bf0ebf623ec4
.quad 0x3f0e3f6dbe48bf80,0x3f7b3ec4bf55bf35,0xbf223f0e3f75248d,0x3ef13f7b3dc9bf6d
.quad 0xbf6dbf353ec43f80,0xbec43f353f6d248d,0x3dc9bf55bf62a554,0xbf75be483f463f6d
.quad 0x3f7b3ec4bf0ebf80,0xbf55bf6dbe483f35,0x3ef13f7b3f46248d,0xbdc9bf55bf75bec4
.quad 0xbf35a5543f353f80,0x3f35248dbf35bf80,0xbf62bf7bbf22a554,0x3f7f3f553e95bec4
.quad 0x3e48bec4bf55bf80,0x3f0e3f6d3f7b3f35,0x3f7f3f553ef1248d,0xbe953e483f223f6d
.quad 0x3ec43f353f6d3f80,0xbf6dbf35bec4a554,0xbf46bf0ebe95a554,0xbf62bf7bbf7fbf6d
.quad 0xbf55bf6dbf7bbf80,0xbe48bec4bf0ebf35,0x3e953e483dc9248d,0x3f223f0e3ef13ec4
.quad 0xbf803f80bf803f80,0xbf803f80bf803f80,0xbf623f55bf463f35,0xbf7f3f7bbf753f6d
.quad 0xbf0e3ec4be48a554,0xbf7b3f6dbf553f35,0xbdc9be483ef1bf35,0xbf753f55bf223ec4
.quad 0x3ec4bf353f6dbf80,0xbf6d3f35bec4a554,0x3f46bf7b3f75bf35,0xbf623f0ebdc9bec4
.quad 0x3f7bbf6d3f0e248d,0xbf553ec43e48bf35,0x3f75bf0ebdc93f35,0xbf463e483ef1bf6d
.quad 0x3f35248dbf353f80,0xbf35a5543f35bf80,0x3e953f0ebf7f3f35,0xbf22be483f62bf6d
.quad 0xbe483f6dbf55a554,0xbf0ebec43f7bbf35,0xbf223f7bbe95bf35,0xbef1bf0e3f7fbec4
.quad 0xbf6d3f353ec4bf80,0xbec4bf353f6d248d,0xbf7f3e483f62bf35,0xbe95bf553f463ec4
.quad 0xbf55bec43f7b248d,0xbe48bf6d3f0e3f35,0xbef1bf553f223f35,0xbdc9bf7b3e953f6d
.quad 0x248dbf80a5543f80,0x248dbf80a5543f80,0x3ef1bf55bf223f35,0x3dc9bf7bbe953f6d
.quad 0x3f55bec4bf7ba554,0x3e48bf6dbf0e3f35,0x3f7f3e48bf62bf35,0x3e95bf55bf463ec4
.quad 0x3f6d3f35bec4bf80,0x3ec4bf35bf6da554,0x3f223f7b3e95bf35,0x3ef1bf0ebf7fbec4
.quad 0x3e483f6d3f55248d,0x3f0ebec4bf7bbf35,0xbe953f0e3f7f3f35,0x3f22be48bf62bf6d
.quad 0xbf35a5543f353f80,0x3f35248dbf35bf80,0xbf75bf0e3dc93f35,0x3f463e48bef1bf6d
.quad 0xbf7bbf6dbf0ea554,0x3f553ec4be48bf35,0xbf46bf7bbf75bf35,0x3f623f0e3dc9bec4
.quad 0xbec4bf35bf6dbf80,0x3f6d3f353ec4248d,0x3dc9be48bef1bf35,0x3f753f553f223ec4
.quad 0x3f0e3ec43e48248d,0x3f7b3f6d3f553f35,0x3f623f553f463f35,0x3f7f3f7b3f753f6d
.quad 0xa50d8000a50d8000,0xa50d8000a50d8000,0x3e95be483dc98000,0x3f22bf0e3ef1bec4
.quad 0x3f0ebec43e488000,0x3f7bbf6d3f55bf35,0x3f46bf0e3e958000,0x3f62bf7b3f7fbf6d
.quad 0x3f6dbf353ec48000,0x3ec4bf353f6dbf80,0x3f7fbf553ef18000,0xbe95be483f22bf6d
.quad 0x3f7bbf6d3f0e8000,0xbf553ec43e48bf35,0x3f62bf7b3f228000,0xbf7f3f55be95bec4
.quad 0x3f35bf803f358000,0xbf353f80bf35a50d,0x3ef1bf7b3f468000,0xbdc93f55bf753ec4
.quad 0x3e48bf6d3f558000,0x3f0e3ec4bf7b3f35,0xbdc9bf553f628000,0x3f75be48bf463f6d
.quad 0xbec4bf353f6d8000,0x3f6dbf35bec43f80,0xbf22bf0e3f758000,0x3ef1bf7b3dc93f6d
.quad 0xbf55bec43f7b8000,0xbe48bf6d3f0e3f35,0xbf75be483f7f8000,0xbf46bf0e3f623ec4
.quad 0xbf80a50d3f808000,0xbf80a50d3f808000,0xbf753e483f7f8000,0xbf463f0e3f62bec4
.quad 0xbf553ec43f7b8000,0xbe483f6d3f0ebf35,0xbf223f0e3f758000,0x3ef13f7b3dc9bf6d
.quad 0xbec43f353f6d8000,0x3f6d3f35bec4bf80,0xbdc93f553f628000,0x3f753e48bf46bf6d
.quad 0x3e483f6d3f558000,0x3f0ebec4bf7bbf35,0x3ef13f7b3f468000,0xbdc9bf55bf75bec4
.quad 0x3f353f803f358000,0xbf35bf80bf35a50d,0x3f623f7b3f228000,0xbf7fbf55be953ec4
.quad 0x3f7b3f6d3f0e8000,0xbf55bec43e483f35,0x3f7f3f553ef18000,0xbe953e483f223f6d
.quad 0x3f6d3f353ec48000,0x3ec43f353f6d3f80,0x3f463f0e3e958000,0x3f623f7b3f7f3f6d
.quad 0x3f0e3ec43e488000,0x3f7b3f6d3f553f35,0x3e953e483dc98000,0x3f223f0e3ef13ec4
.quad 0xa50d8000a50d8000,0xa50d8000a50d8000,0x3f62bf553f46bf35,0x3f7fbf7b3f75bf6d
.quad 0x3f55bf6d3f7bbf80,0x3e48bec43f0ebf35,0xbdc9be483ef1bf35,0xbf753f55bf223ec4
.quad 0xbf6d3f35bec4a50d,0xbec43f35bf6d3f80,0xbf463f7bbf753f35,0x3f62bf0e3dc93ec4
.quad 0x3e483ec4bf553f80,0x3f0ebf6d3f7bbf35,0x3f75bf0ebdc93f35,0xbf463e483ef1bf6d
.quad 0x3f35bf803f358000,0xbf353f80bf35a50d,0xbe95bf0e3f7fbf35,0x3f223e48bf623f6d
.quad 0xbf7b3ec43f0ebf80,0x3f55bf6d3e483f35,0xbf223f7bbe95bf35,0xbef1bf0e3f7fbec4
.quad 0x3ec43f35bf6da50d,0xbf6d3f353ec4bf80,0x3f7fbe48bf623f35,0x3e953f55bf46bec4
.quad 0x3f0ebf6dbe483f80,0x3f7bbec4bf553f35,0xbef1bf553f223f35,0xbdc9bf7b3e953f6d
.quad 0xbf80a50d3f808000,0xbf80a50d3f808000,0xbef13f553f22bf35,0xbdc93f7b3e95bf6d
.quad 0x3f0e3f6dbe48bf80,0x3f7b3ec4bf55bf35,0x3f7f3e48bf62bf35,0x3e95bf55bf463ec4
.quad 0x3ec4bf35bf6da50d,0xbf6dbf353ec43f80,0xbf22bf7bbe953f35,0xbef13f0e3f7f3ec4
.quad 0xbf7bbec43f0e3f80,0x3f553f6d3e48bf35,0xbe953f0e3f7f3f35,0x3f22be48bf62bf6d
.quad 0x3f353f803f358000,0xbf35bf80bf35a50d,0x3f753f0ebdc9bf35,0xbf46be483ef13f6d
.quad 0x3e48bec4bf55bf80,0x3f0e3f6d3f7b3f35,0xbf46bf7bbf75bf35,0x3f623f0e3dc9bec4
.quad 0xbf6dbf35bec4a50d,0xbec4bf35bf6dbf80,0xbdc93e483ef13f35,0xbf75bf55bf22bec4
.quad 0x3f553f6d3f7b3f80,0x3e483ec43f0e3f35,0x3f623f553f463f35,0x3f7f3f7b3f753f6d
.quad 0xa50d8000a50d8000,0xa50d8000a50d8000,0x3f75bf7b3f7fbf80,0x3f46bf553f62bf6d
.quad 0xbf0e3ec4be48a50d,0xbf7b3f6dbf553f35,0xbf223f55bf753f80,0x3ef1be48bdc93ec4
.quad 0x3f6dbf353ec48000,0x3ec4bf353f6dbf80,0x3dc9bf0e3f62bf80,0xbf753f7bbf463ec4
.quad 0xbf7b3f6dbf0ea50d,0x3f55bec4be483f35,0x3ef13e48bf463f80,0xbdc9bf0e3f75bf6d
.quad 0x3f35bf803f358000,0xbf353f80bf35a50d,0xbf623e483f22bf80,0x3f7fbf0ebe953f6d
.quad 0xbe483f6dbf55a50d,0xbf0ebec43f7bbf35,0x3f7fbf0ebef13f80,0xbe953f7bbf22bec4
.quad 0xbec4bf353f6d8000,0x3f6dbf35bec43f80,0xbf463f553e95bf80,0xbf62be483f7fbec4
.quad 0x3f553ec4bf7ba50d,0x3e483f6dbf0ebf35,0x3e95bf7bbdc93f80,0x3f22bf55bef13f6d
.quad 0xbf80a50d3f808000,0xbf80a50d3f808000,0x3e953f7bbdc9bf80,0x3f223f55bef1bf6d
.quad 0x3f55bec4bf7ba50d,0x3e48bf6dbf0e3f35,0xbf46bf553e953f80,0xbf623e483f7f3ec4
.quad 0xbec43f353f6d8000,0x3f6d3f35bec4bf80,0x3f7f3f0ebef1bf80,0xbe95bf7bbf223ec4
.quad 0xbe48bf6dbf55a50d,0xbf0e3ec43f7b3f35,0xbf62be483f223f80,0x3f7f3f0ebe95bf6d
.quad 0x3f353f803f358000,0xbf35bf80bf35a50d,0x3ef1be48bf46bf80,0xbdc93f0e3f753f6d
.quad 0xbf7bbf6dbf0ea50d,0x3f553ec4be48bf35,0x3dc93f0e3f623f80,0xbf75bf7bbf46bec4
.quad 0x3f6d3f353ec48000,0x3ec43f353f6d3f80,0xbf22bf55bf75bf80,0x3ef13e48bdc9bec4
.quad 0xbf0ebec4be48a50d,0xbf7bbf6dbf55bf35,0x3f753f7b3f7f3f80,0x3f463f553f623f6d
.quad 0xa50d8000a50d8000,0xa50d8000a50d8000,0x3ef1bf0e3f22bf35,0x3dc9be483e95bec4
.quad 0xbf553f6dbf7b3f80,0xbe483ec4bf0e3f35,0x3f7fbf7b3f62bf35,0x3e95bf0e3f46bf6d
.quad 0xbf6d3f35bec4a50d,0xbec43f35bf6d3f80,0x3f22be48be953f35,0x3ef1bf553f7fbf6d
.quad 0xbe48bec43f55bf80,0xbf0e3f6dbf7b3f35,0xbe953f55bf7f3f35,0x3f22bf7b3f62bec4
.quad 0x3f35bf803f358000,0xbf353f80bf35a50d,0xbf753f55bdc9bf35,0x3f46bf7b3ef13ec4
.quad 0x3f7bbec4bf0e3f80,0xbf553f6dbe48bf35,0xbf46be483f75bf35,0x3f62bf55bdc93f6d
.quad 0x3ec43f35bf6da50d,0xbf6d3f353ec4bf80,0x3dc9bf7b3ef13f35,0x3f75bf0ebf223f6d
.quad 0xbf0e3f6d3e48bf80,0xbf7b3ec43f55bf35,0x3f62bf0ebf463f35,0x3f7fbe48bf753ec4
.quad 0xbf80a50d3f808000,0xbf80a50d3f808000,0x3f623f0ebf46bf35,0x3f7f3e48bf75bec4
.quad 0xbf0ebf6d3e483f80,0xbf7bbec43f553f35,0x3dc93f7b3ef1bf35,0x3f753f0ebf22bf6d
.quad 0x3ec4bf35bf6da50d,0xbf6dbf353ec43f80,0xbf463e483f753f35,0x3f623f55bdc9bf6d
.quad 0x3f7b3ec4bf0ebf80,0xbf55bf6dbe483f35,0xbf75bf55bdc93f35,0x3f463f7b3ef1bec4
.quad 0x3f353f803f358000,0xbf35bf80bf35a50d,0xbe95bf55bf7fbf35,0x3f223f7b3f623ec4
.quad 0xbe483ec43f553f80,0xbf0ebf6dbf7bbf35,0x3f223e48be95bf35,0x3ef13f553f7f3f6d
.quad 0xbf6dbf35bec4a50d,0xbec4bf35bf6dbf80,0x3f7f3f7b3f623f35,0x3e953f0e3f463f6d
.quad 0xbf55bf6dbf7bbf80,0xbe48bec4bf0ebf35,0x3ef13f0e3f223f35,0x3dc93e483e953ec4
.quad 0xa50d8000a50d8000,0xa50d8000a50d8000,0xbe953e48bdc9a50d,0xbf223f0ebef13ec4
.quad 0x3f0ebec43e488000,0x3f7bbf6d3f55bf35,0xbf463f0ebe95a50d,0xbf623f7bbf7f3f6d
.quad 0x3f6dbf353ec48000,0x3ec4bf353f6dbf80,0xbf7f3f55bef1a50d,0x3e953e48bf223f6d
.quad 0x3f7bbf6d3f0e8000,0xbf553ec43e48bf35,0xbf623f7bbf22a50d,0x3f7fbf553e953ec4
.quad 0x3f35bf803f358000,0xbf353f80bf35a50d,0xbef13f7bbf46a50d,0x3dc9bf553f75bec4
.quad 0x3e48bf6d3f558000,0x3f0e3ec4bf7b3f35,0x3dc93f55bf62a50d,0xbf753e483f46bf6d
.quad 0xbec4bf353f6d8000,0x3f6dbf35bec43f80,0x3f223f0ebf75a50d,0xbef13f7bbdc9bf6d
.quad 0xbf55bec43f7b8000,0xbe48bf6d3f0e3f35,0x3f753e48bf7fa50d,0x3f463f0ebf62bec4
.quad 0xbf80a50d3f808000,0xbf80a50d3f808000,0x3f75be48bf7fa50d,0x3f46bf0ebf623ec4
.quad 0xbf553ec43f7b8000,0xbe483f6d3f0ebf35,0x3f22bf0ebf75a50d,0xbef1bf7bbdc93f6d
.quad 0xbec43f353f6d8000,0x3f6d3f35bec4bf80,0x3dc9bf55bf62a50d,0xbf75be483f463f6d
.quad 0x3e483f6d3f558000,0x3f0ebec4bf7bbf35,0xbef1bf7bbf46a50d,0x3dc93f553f753ec4
.quad 0x3f353f803f358000,0xbf35bf80bf35a50d,0xbf62bf7bbf22a50d,0x3f7f3f553e95bec4
.quad 0x3f7b3f6d3f0e8000,0xbf55bec43e483f35,0xbf7fbf55bef1a50d,0x3e95be48bf22bf6d
.quad 0x3f6d3f353ec48000,0x3ec43f353f6d3f80,0xbf46bf0ebe95a50d,0xbf62bf7bbf7fbf6d
.quad 0x3f0e3ec43e488000,0x3f7b3f6d3f553f35,0xbe95be48bdc9a50d,0xbf22bf0ebef1bec4
.quad 0xa50d8000a50d8000,0xa50d8000a50d8000,0xbf623f55bf463f35,0xbf7f3f7bbf753f6d
.quad 0x3f55bf6d3f7bbf80,0x3e48bec43f0ebf35,0x3dc93e48bef13f35,0x3f75bf553f22bec4
.quad 0xbf6d3f35bec4a50d,0xbec43f35bf6d3f80,0x3f46bf7b3f75bf35,0xbf623f0ebdc9bec4
.quad 0x3e483ec4bf553f80,0x3f0ebf6d3f7bbf35,0xbf753f0e3dc9bf35,0x3f46be48bef13f6d
.quad 0x3f35bf803f358000,0xbf353f80bf35a50d,0x3e953f0ebf7f3f35,0xbf22be483f62bf6d
.quad 0xbf7b3ec43f0ebf80,0x3f55bf6d3e483f35,0x3f22bf7b3e953f35,0x3ef13f0ebf7f3ec4
.quad 0x3ec43f35bf6da50d,0xbf6d3f353ec4bf80,0xbf7f3e483f62bf35,0xbe95bf553f463ec4
.quad 0x3f0ebf6dbe483f80,0x3f7bbec4bf553f35,0x3ef13f55bf22bf35,0x3dc93f7bbe95bf6d
.quad 0xbf80a50d3f808000,0xbf80a50d3f808000,0x3ef1bf55bf223f35,0x3dc9bf7bbe953f6d
.quad 0x3f0e3f6dbe48bf80,0x3f7b3ec4bf55bf35,0xbf7fbe483f623f35,0xbe953f553f46bec4
.quad 0x3ec4bf35bf6da50d,0xbf6dbf353ec43f80,0x3f223f7b3e95bf35,0x3ef1bf0ebf7fbec4
.quad 0xbf7bbec43f0e3f80,0x3f553f6d3e48bf35,0x3e95bf0ebf7fbf35,0xbf223e483f623f6d
.quad 0x3f353f803f358000,0xbf35bf80bf35a50d,0xbf75bf0e3dc93f35,0x3f463e48bef1bf6d
.quad 0x3e48bec4bf55bf80,0x3f0e3f6d3f7b3f35,0x3f463f7b3f753f35,0xbf62bf0ebdc93ec4
.quad 0xbf6dbf35bec4a50d,0xbec4bf35bf6dbf80,0x3dc9be48bef1bf35,0x3f753f553f223ec4
.quad 0x3f553f6d3f7b3f80,0x3e483ec43f0e3f35,0xbf62bf55bf46bf35,0xbf7fbf7bbf75bf6d
.quad 0xa50d8000a50d8000,0xa50d8000a50d8000,0xbf753f7bbf7f3f80,0xbf463f55bf623f6d
.quad 0xbf0e3ec4be48a50d,0xbf7b3f6dbf553f35,0x3f22bf553f75bf80,0xbef13e483dc9bec4
.quad 0x3f6dbf353ec48000,0x3ec4bf353f6dbf80,0xbdc93f0ebf623f80,0x3f75bf7b3f46bec4
.quad 0xbf7b3f6dbf0ea50d,0x3f55bec4be483f35,0xbef1be483f46bf80,0x3dc93f0ebf753f6d
.quad 0x3f35bf803f358000,0xbf353f80bf35a50d,0x3f62be48bf223f80,0xbf7f3f0e3e95bf6d
.quad 0xbe483f6dbf55a50d,0xbf0ebec43f7bbf35,0xbf7f3f0e3ef1bf80,0x3e95bf7b3f223ec4
.quad 0xbec4bf353f6d8000,0x3f6dbf35bec43f80,0x3f46bf55be953f80,0x3f623e48bf7f3ec4
.quad 0x3f553ec4bf7ba50d,0x3e483f6dbf0ebf35,0xbe953f7b3dc9bf80,0xbf223f553ef1bf6d
.quad 0xbf80a50d3f808000,0xbf80a50d3f808000,0xbe95bf7b3dc93f80,0xbf22bf553ef13f6d
.quad 0x3f55bec4bf7ba50d,0x3e48bf6dbf0e3f35,0x3f463f55be95bf80,0x3f62be48bf7fbec4
.quad 0xbec43f353f6d8000,0x3f6d3f35bec4bf80,0xbf7fbf0e3ef13f80,0x3e953f7b3f22bec4
.quad 0xbe48bf6dbf55a50d,0xbf0e3ec43f7b3f35,0x3f623e48bf22bf80,0xbf7fbf0e3e953f6d
.quad 0x3f353f803f358000,0xbf35bf80bf35a50d,0xbef13e483f463f80,0x3dc9bf0ebf75bf6d
.quad 0xbf7bbf6dbf0ea50d,0x3f553ec4be48bf35,0xbdc9bf0ebf62bf80,0x3f753f7b3f463ec4
.quad 0x3f6d3f353ec48000,0x3ec43f353f6d3f80,0x3f223f553f753f80,0xbef1be483dc93ec4
.quad 0xbf0ebec4be48a50d,0xbf7bbf6dbf55bf35,0xbf75bf7bbf7fbf80,0xbf46bf55bf62bf6d
.quad 0xa50d8000a50d8000,0xa50d8000a50d8000,0xbef13f0ebf223f35,0xbdc93e48be953ec4
.quad 0xbf553f6dbf7b3f80,0xbe483ec4bf0e3f35,0xbf7f3f7bbf623f35,0xbe953f0ebf463f6d
.quad 0xbf6d3f35bec4a50d,0xbec43f35bf6d3f80,0xbf223e483e95bf35,0xbef13f55bf7f3f6d
.quad 0xbe48bec43f55bf80,0xbf0e3f6dbf7b3f35,0x3e95bf553f7fbf35,0xbf223f7bbf623ec4
.quad 0x3f35bf803f358000,0xbf353f80bf35a50d,0x3f75bf553dc93f35,0xbf463f7bbef1bec4
.quad 0x3f7bbec4bf0e3f80,0xbf553f6dbe48bf35,0x3f463e48bf753f35,0xbf623f553dc9bf6d
.quad 0x3ec43f35bf6da50d,0xbf6d3f353ec4bf80,0xbdc93f7bbef1bf35,0xbf753f0e3f22bf6d
.quad 0xbf0e3f6d3e48bf80,0xbf7b3ec43f55bf35,0xbf623f0e3f46bf35,0xbf7f3e483f75bec4
.quad 0xbf80a50d3f808000,0xbf80a50d3f808000,0xbf62bf0e3f463f35,0xbf7fbe483f753ec4
.quad 0xbf0ebf6d3e483f80,0xbf7bbec43f553f35,0xbdc9bf7bbef13f35,0xbf75bf0e3f223f6d
.quad 0x3ec4bf35bf6da50d,0xbf6dbf353ec43f80,0x3f46be48bf75bf35,0xbf62bf553dc93f6d
.quad 0x3f7b3ec4bf0ebf80,0xbf55bf6dbe483f35,0x3f753f553dc9bf35,0xbf46bf7bbef13ec4
.quad 0x3f353f803f358000,0xbf35bf80bf35a50d,0x3e953f553f7f3f35,0xbf22bf7bbf62bec4
.quad 0xbe483ec43f553f80,0xbf0ebf6dbf7bbf35,0xbf22be483e953f35,0xbef1bf55bf7fbf6d
.quad 0xbf6dbf35bec4a50d,0xbec4bf35bf6dbf80,0xbf7fbf7bbf62bf35,0xbe95bf0ebf46bf6d
.quad 0xbf55bf6dbf7bbf80,0xbe48bec4bf0ebf35,0xbef1bf0ebf22bf35,0xbdc9be48be95bec4
dft_tab_end:
.size dft_tab, dft_tab_end-dft_tab
.section .rodata,"a"
.p2align 6
.amdhsa_kernel concat_heads__grouped_kv_mqa__spectral_fnet__prompt_kernel
  .amdhsa_next_free_vgpr 168
  .amdhsa_next_free_sgpr 102
  .amdhsa_accum_offset 168
  .amdhsa_group_segment_fixed_size 0
  .amdhsa_kernarg_size 104
  .amdhsa_user_sgpr_count 2
  .amdhsa_user_sgpr_kernarg_segment_ptr 1
  .amdhsa_system_sgpr_workgroup_id_x 1
.end_amdhsa_kernel
```
